```python
import torch

def _softmax(x, axis=-1):
    return torch.softmax(x, dim=axis)
def _gelu(x):
    return torch.nn.functional.gelu(x, approximate="tanh")
def _silu(x):
    return torch.nn.functional.silu(x)
def _sigmoid(x):
    return torch.sigmoid(x)
def _layernorm(x, axis=-1, eps=1e-5):
    m = x.mean(dim=axis, keepdim=True)
    v = x.var(dim=axis, keepdim=True, unbiased=False)
    return (x - m) / torch.sqrt(v + eps)
def _scatter_add(tgt, idx, src, axis=0):
    return tgt.clone().index_add_(axis, idx, src)
def _segment_sum(src, seg, n):
    out = torch.zeros((n,) + src.shape[1:], dtype=src.dtype)
    return out.index_add_(0, seg, src)
def _pad(x, pw):
    flat = tuple(v for pair in reversed(pw) for v in pair)
    return torch.nn.functional.pad(x, flat)

kernel_name = 'parallel_sum__softmax_full_mha__dense_activation_mish__prompt'

def setup_inputs():

    _w = (lambda a: (lambda t: t.to(torch.bfloat16) if t.is_floating_point() else t)(torch.as_tensor(a)))
    def _A_setup():
        B, S, D = 1, 2048, 512
        return {
            "x": _w((lambda *s: torch.randn(*s, dtype=torch.bfloat16) * 0.05)(B, S, D)),
            "wqkv": _w((lambda *s: torch.randn(*s, dtype=torch.bfloat16) * 0.05)(D, 3 * D)),
            "wo": _w((lambda *s: torch.randn(*s, dtype=torch.bfloat16) * 0.05)(D, D)),
        }
    _A_in = _A_setup()

    def _B_setup():
        B, S, D, F = 1, 2048, 512, 1792
        return {
            "x": _w((lambda *s: torch.randn(*s, dtype=torch.bfloat16) * 0.05)(B, S, D)),
            "w1": _w((lambda *s: torch.randn(*s, dtype=torch.bfloat16) * 0.8)(D, F) * (D ** -0.5)),
            "b1": _w((lambda *s: torch.randn(*s, dtype=torch.bfloat16) * 0.8)(F)),
            "w2": _w((lambda *s: torch.randn(*s, dtype=torch.bfloat16) * 0.2)(F, D) * (F ** -0.5)),
        }
    _B_in = _B_setup()

    return {
        "A_x": _A_in["x"],
        "A_wqkv": _A_in["wqkv"],
        "A_wo": _A_in["wo"],
        "B_x": _B_in["x"],
        "B_w1": _B_in["w1"],
        "B_b1": _B_in["b1"],
        "B_w2": _B_in["w2"],
    }

def reference(A_x, A_wqkv, A_wo, B_x, B_w1, B_b1, B_w2):
    def _A_ref(x, wqkv, wo):
        B, S, D = x.shape
        H = 32; Dh = D // H
        qkv = (lambda x, *d: x.permute(*d))((x @ wqkv).reshape(B, S, 3, H, Dh), 2, 0, 3, 1, 4)
        q, k, v = qkv[0], qkv[1], qkv[2]
        scale = Dh ** -0.5
        scores = torch.einsum("bhqd,bhkd->bhqk", q, k) * scale
        p = _softmax(scores, axis=-1)
        o = torch.einsum("bhqk,bhkd->bhqd", p, v)
        return (lambda x, *d: x.permute(*d))(o, 0, 2, 1, 3).reshape(B, S, D) @ wo

    def _B_ref(x, w1, b1, w2):
        h = torch.einsum("bsd,df->bsf", x, w1) + b1
        sp = torch.log1p(torch.exp(-torch.abs(h))) + torch.where(h > 0, h, torch.zeros_like(h))
        act = h * torch.tanh(sp)
        return torch.einsum("bsf,fd->bsd", act, w2)

    x = A_x
    xn = _layernorm(x, axis=-1)
    return x + _A_ref(xn, A_wqkv, A_wo) + _B_ref(xn, B_w1, B_b1, B_w2)
```

```asm
; @launch kernel=lnqkv_kernel grid=(256,1,1) block=(384,1,1) lds=163840
; @launch kernel=parallel_sum__softmax_full_mha__dense_activation_mish__prompt_kernel grid=(256,1,1) block=(768,1,1) lds=159808
.amdgcn_target "amdgcn-amd-amdhsa--gfx950"
.text
.globl lnqkv_kernel
.p2align 8
.type lnqkv_kernel,@function
lnqkv_kernel:
  s_cmp_ge_u32 s2, 256
  s_cbranch_scc1 lnqkv_kernel_end
  s_load_dwordx4 s[48:51], s[0:1], 0
  s_load_dwordx2 s[52:53], s[0:1], 16
  s_load_dwordx4 s[56:59], s[0:1], 32
  s_load_dwordx2 s[60:61], s[0:1], 48
  s_load_dwordx2 s[62:63], s[0:1], 72
  v_lshrrev_b32 v8, 6, v0
  v_and_b32 v1, 63, v0
  v_readfirstlane_b32 s32, v8
  v_lshlrev_b32 v1, 4, v1
  s_lshr_b32 s4, s2, 3
  s_bfe_u32 s3, s2, 0x20001
  s_lshl_b32 s3, s3, 2
  s_and_b32 s5, s4, 3
  s_add_u32 s33, s3, s5
  s_and_b32 s3, s2, 1
  s_lshl_b32 s3, s3, 3
  s_lshr_b32 s4, s4, 2
  s_add_u32 s34, s3, s4
  s_mul_i32 s4, s34, 6
  s_sub_u32 s5, s34, 6
  s_cmp_ge_u32 s34, 6
  s_cselect_b32 s5, s5, 0
  s_cselect_b32 s6, 5, 6
  s_sub_u32 s4, s4, s5
  s_sub_u32 s5, s34, 10
  s_lshl_b32 s5, s5, 3
  s_cmp_lt_u32 s34, 10
  s_cselect_b32 s35, s4, s5
  s_cselect_b32 s36, s6, 8
  s_movk_i32 s4, 3072
  s_cselect_b32 s44, 3584, s4
  s_and_b32 s3, s35, 1
  s_add_u32 s3, s3, s36
  s_add_u32 s3, s3, 1
  s_lshr_b32 s45, s3, 1
  s_lshl_b32 s37, s33, 2
  s_add_u32 s37, s37, s32
  s_waitcnt lgkmcnt(0)
  s_cmp_ge_u32 s32, 4
  s_cbranch_scc1 lnqkv_kernel_loader
  s_mov_b32 s8, s48
  s_and_b32 s9, s49, 0xffff
  s_mov_b32 s10, 0x200000
  s_mov_b32 s11, 0x00020000
  v_bfe_u32 v8, v0, 3, 3
  v_lshlrev_b32 v8, 10, v8
  v_and_b32 v9, 7, v0
  v_bfe_u32 v10, v0, 4, 2
  v_xor_b32 v9, v9, v10
  v_lshlrev_b32 v9, 4, v9
  v_add_u32 v12, v8, v9
  v_xor_b32 v13, 64, v12
  s_lshl_b32 s3, s32, 15
  s_add_u32 s3, s3, 32768
  s_lshl_b32 s4, s37, 15
  s_mov_b32 s6, s3
  s_mov_b32 s7, s4
  s_mov_b32 s42, 4
lnqkv_kernel_xl:
  s_mov_b32 m0, s6
  s_mov_b32 s5, s7
  buffer_load_dwordx4 v12, s[8:11], s5 offen lds
  s_add_u32 m0, s6, 1024
  s_add_u32 s5, s7, 8192
  buffer_load_dwordx4 v13, s[8:11], s5 offen lds
  s_add_u32 m0, s6, 2048
  s_add_u32 s5, s7, 16384
  buffer_load_dwordx4 v12, s[8:11], s5 offen lds
  s_add_u32 m0, s6, 3072
  s_add_u32 s5, s7, 24576
  buffer_load_dwordx4 v13, s[8:11], s5 offen lds
  s_add_u32 s6, s6, 4096
  s_add_u32 s7, s7, 128
  s_sub_u32 s42, s42, 1
  s_cmp_lg_u32 s42, 0
  s_cbranch_scc1 lnqkv_kernel_xl
  s_mov_b32 s16, s62
  s_and_b32 s17, s63, 0xffff
  s_mov_b32 s18, 0x10000000
  s_mov_b32 s19, 0x00020000
  v_and_b32 v8, 31, v0
  v_bfe_u32 v9, v0, 5, 1
  v_lshlrev_b32 v9, 3, v9
  v_sub_u32 v8, v8, v9
  v_mov_b32 v10, 0x3f80
  v_mov_b32 v11, 0x3f800000
  v_cmp_eq_u32 vcc, 0, v8
  v_cmp_eq_u32 s[42:43], 1, v8
  v_mov_b32 v108, 0
  v_mov_b32 v100, 0
  v_cndmask_b32 v108, v108, v10, vcc
  v_cndmask_b32 v108, v108, v11, s[42:43]
  v_mov_b32 v104, 0
  v_cmp_eq_u32 vcc, 2, v8
  v_cmp_eq_u32 s[42:43], 3, v8
  v_mov_b32 v109, 0
  v_mov_b32 v101, 0
  v_cndmask_b32 v109, v109, v10, vcc
  v_cndmask_b32 v109, v109, v11, s[42:43]
  v_mov_b32 v105, 0
  v_cmp_eq_u32 vcc, 4, v8
  v_cmp_eq_u32 s[42:43], 5, v8
  v_mov_b32 v110, 0
  v_mov_b32 v102, 0
  v_cndmask_b32 v110, v110, v10, vcc
  v_cndmask_b32 v110, v110, v11, s[42:43]
  v_mov_b32 v106, 0
  v_cmp_eq_u32 vcc, 6, v8
  v_cmp_eq_u32 s[42:43], 7, v8
  v_mov_b32 v111, 0
  v_mov_b32 v103, 0
  v_cndmask_b32 v111, v111, v10, vcc
  v_cndmask_b32 v111, v111, v11, s[42:43]
  v_mov_b32 v107, 0
  v_bfe_u32 v8, v0, 3, 2
  v_lshlrev_b32 v8, 10, v8
  v_and_b32 v9, 7, v0
  v_lshlrev_b32 v9, 7, v9
  v_add_u32 v8, v8, v9
  v_bfe_u32 v9, v0, 1, 3
  v_bfe_u32 v10, v0, 5, 1
  v_xor_b32 v9, v9, v10
  v_lshlrev_b32 v9, 4, v9
  v_add_u32 v8, v8, v9
  v_add_u32 v8, s3, v8
  v_xor_b32 v80, 0, v8
  v_xor_b32 v81, 32, v8
  v_xor_b32 v82, 64, v8
  v_xor_b32 v83, 96, v8
  v_bfe_u32 v8, v0, 5, 1
  v_lshlrev_b32 v8, 2, v8
  v_bfe_u32 v10, v0, 2, 2
  v_add_u32 v8, v8, v10
  v_lshlrev_b32 v8, 7, v8
  v_bfe_u32 v10, v0, 4, 1
  v_lshlrev_b32 v10, 1, v10
  v_bfe_u32 v11, v0, 1, 1
  v_add_u32 v10, v10, v11
  v_bfe_u32 v11, v0, 3, 1
  v_lshlrev_b32 v11, 2, v11
  v_xor_b32 v10, v10, v11
  v_lshlrev_b32 v10, 4, v10
  v_add_u32 v8, v8, v10
  v_and_b32 v10, 1, v0
  v_lshlrev_b32 v10, 3, v10
  v_add_u32 v2, v8, v10
  s_and_b32 s42, s35, 1
  s_lshl_b32 s42, s42, 6
  v_xor_b32 v2, s42, v2
  v_mov_b32 v11, 0x3f803f80
  v_mov_b32 v16, 0
  v_mov_b32 v17, 0
  v_mov_b32 v18, 0
  v_mov_b32 v19, 0
  v_mov_b32 v20, 0
  v_mov_b32 v21, 0
  v_mov_b32 v22, 0
  v_mov_b32 v23, 0
  v_mov_b32 v24, 0
  v_mov_b32 v25, 0
  v_mov_b32 v26, 0
  v_mov_b32 v27, 0
  v_mov_b32 v28, 0
  v_mov_b32 v29, 0
  v_mov_b32 v30, 0
  v_mov_b32 v31, 0
  s_mov_b32 m0, s6
  s_mov_b32 s5, s7
  buffer_load_dwordx4 v12, s[8:11], s5 offen lds
  s_add_u32 m0, s6, 1024
  s_add_u32 s5, s7, 8192
  buffer_load_dwordx4 v13, s[8:11], s5 offen lds
  s_add_u32 m0, s6, 2048
  s_add_u32 s5, s7, 16384
  buffer_load_dwordx4 v12, s[8:11], s5 offen lds
  s_add_u32 m0, s6, 3072
  s_add_u32 s5, s7, 24576
  buffer_load_dwordx4 v13, s[8:11], s5 offen lds
  s_add_u32 s6, s6, 4096
  s_add_u32 s7, s7, 128
  s_waitcnt vmcnt(16)
  ds_read_b128 v[128:131], v80 offset:0
  ds_read_b128 v[132:135], v81 offset:0
  ds_read_b128 v[136:139], v82 offset:0
  ds_read_b128 v[140:143], v83 offset:0
  s_mov_b32 m0, s6
  s_mov_b32 s5, s7
  buffer_load_dwordx4 v12, s[8:11], s5 offen lds
  s_add_u32 m0, s6, 1024
  s_add_u32 s5, s7, 8192
  buffer_load_dwordx4 v13, s[8:11], s5 offen lds
  s_add_u32 m0, s6, 2048
  s_add_u32 s5, s7, 16384
  buffer_load_dwordx4 v12, s[8:11], s5 offen lds
  s_add_u32 m0, s6, 3072
  s_add_u32 s5, s7, 24576
  buffer_load_dwordx4 v13, s[8:11], s5 offen lds
  s_add_u32 s6, s6, 4096
  s_add_u32 s7, s7, 128
  s_waitcnt vmcnt(16)
  ds_read_b128 v[144:147], v80 offset:4096
  ds_read_b128 v[148:151], v81 offset:4096
  ds_read_b128 v[152:155], v82 offset:4096
  ds_read_b128 v[156:159], v83 offset:4096
  s_waitcnt lgkmcnt(4)
  v_dot2c_f32_bf16 v16, v128, v11
  v_dot2c_f32_bf16 v24, v128, v128
  v_dot2c_f32_bf16 v17, v129, v11
  v_dot2c_f32_bf16 v25, v129, v129
  v_dot2c_f32_bf16 v18, v130, v11
  v_dot2c_f32_bf16 v26, v130, v130
  v_dot2c_f32_bf16 v19, v131, v11
  v_dot2c_f32_bf16 v27, v131, v131
  v_dot2c_f32_bf16 v20, v132, v11
  v_dot2c_f32_bf16 v28, v132, v132
  v_dot2c_f32_bf16 v21, v133, v11
  v_dot2c_f32_bf16 v29, v133, v133
  v_dot2c_f32_bf16 v22, v134, v11
  v_dot2c_f32_bf16 v30, v134, v134
  v_dot2c_f32_bf16 v23, v135, v11
  v_dot2c_f32_bf16 v31, v135, v135
  v_dot2c_f32_bf16 v16, v136, v11
  v_dot2c_f32_bf16 v24, v136, v136
  v_dot2c_f32_bf16 v17, v137, v11
  v_dot2c_f32_bf16 v25, v137, v137
  v_dot2c_f32_bf16 v18, v138, v11
  v_dot2c_f32_bf16 v26, v138, v138
  v_dot2c_f32_bf16 v19, v139, v11
  v_dot2c_f32_bf16 v27, v139, v139
  v_dot2c_f32_bf16 v20, v140, v11
  v_dot2c_f32_bf16 v28, v140, v140
  v_dot2c_f32_bf16 v21, v141, v11
  v_dot2c_f32_bf16 v29, v141, v141
  v_dot2c_f32_bf16 v22, v142, v11
  v_dot2c_f32_bf16 v30, v142, v142
  v_dot2c_f32_bf16 v23, v143, v11
  v_dot2c_f32_bf16 v31, v143, v143
  s_mov_b32 m0, s6
  s_mov_b32 s5, s7
  buffer_load_dwordx4 v12, s[8:11], s5 offen lds
  s_add_u32 m0, s6, 1024
  s_add_u32 s5, s7, 8192
  buffer_load_dwordx4 v13, s[8:11], s5 offen lds
  s_add_u32 m0, s6, 2048
  s_add_u32 s5, s7, 16384
  buffer_load_dwordx4 v12, s[8:11], s5 offen lds
  s_add_u32 m0, s6, 3072
  s_add_u32 s5, s7, 24576
  buffer_load_dwordx4 v13, s[8:11], s5 offen lds
  s_add_u32 s6, s6, 4096
  s_add_u32 s7, s7, 128
  s_waitcnt vmcnt(16)
  ds_read_b128 v[160:163], v80 offset:8192
  ds_read_b128 v[164:167], v81 offset:8192
  ds_read_b128 v[168:171], v82 offset:8192
  ds_read_b128 v[172:175], v83 offset:8192
  s_waitcnt lgkmcnt(4)
  v_dot2c_f32_bf16 v16, v144, v11
  v_dot2c_f32_bf16 v24, v144, v144
  v_dot2c_f32_bf16 v17, v145, v11
  v_dot2c_f32_bf16 v25, v145, v145
  v_dot2c_f32_bf16 v18, v146, v11
  v_dot2c_f32_bf16 v26, v146, v146
  v_dot2c_f32_bf16 v19, v147, v11
  v_dot2c_f32_bf16 v27, v147, v147
  v_dot2c_f32_bf16 v20, v148, v11
  v_dot2c_f32_bf16 v28, v148, v148
  v_dot2c_f32_bf16 v21, v149, v11
  v_dot2c_f32_bf16 v29, v149, v149
  v_dot2c_f32_bf16 v22, v150, v11
  v_dot2c_f32_bf16 v30, v150, v150
  v_dot2c_f32_bf16 v23, v151, v11
  v_dot2c_f32_bf16 v31, v151, v151
  v_dot2c_f32_bf16 v16, v152, v11
  v_dot2c_f32_bf16 v24, v152, v152
  v_dot2c_f32_bf16 v17, v153, v11
  v_dot2c_f32_bf16 v25, v153, v153
  v_dot2c_f32_bf16 v18, v154, v11
  v_dot2c_f32_bf16 v26, v154, v154
  v_dot2c_f32_bf16 v19, v155, v11
  v_dot2c_f32_bf16 v27, v155, v155
  v_dot2c_f32_bf16 v20, v156, v11
  v_dot2c_f32_bf16 v28, v156, v156
  v_dot2c_f32_bf16 v21, v157, v11
  v_dot2c_f32_bf16 v29, v157, v157
  v_dot2c_f32_bf16 v22, v158, v11
  v_dot2c_f32_bf16 v30, v158, v158
  v_dot2c_f32_bf16 v23, v159, v11
  v_dot2c_f32_bf16 v31, v159, v159
  s_mov_b32 m0, s6
  s_mov_b32 s5, s7
  buffer_load_dwordx4 v12, s[8:11], s5 offen lds
  s_add_u32 m0, s6, 1024
  s_add_u32 s5, s7, 8192
  buffer_load_dwordx4 v13, s[8:11], s5 offen lds
  s_add_u32 m0, s6, 2048
  s_add_u32 s5, s7, 16384
  buffer_load_dwordx4 v12, s[8:11], s5 offen lds
  s_add_u32 m0, s6, 3072
  s_add_u32 s5, s7, 24576
  buffer_load_dwordx4 v13, s[8:11], s5 offen lds
  s_add_u32 s6, s6, 4096
  s_add_u32 s7, s7, 128
  s_waitcnt vmcnt(16)
  ds_read_b128 v[176:179], v80 offset:12288
  ds_read_b128 v[180:183], v81 offset:12288
  ds_read_b128 v[184:187], v82 offset:12288
  ds_read_b128 v[188:191], v83 offset:12288
  s_waitcnt lgkmcnt(4)
  v_dot2c_f32_bf16 v16, v160, v11
  v_dot2c_f32_bf16 v24, v160, v160
  v_dot2c_f32_bf16 v17, v161, v11
  v_dot2c_f32_bf16 v25, v161, v161
  v_dot2c_f32_bf16 v18, v162, v11
  v_dot2c_f32_bf16 v26, v162, v162
  v_dot2c_f32_bf16 v19, v163, v11
  v_dot2c_f32_bf16 v27, v163, v163
  v_dot2c_f32_bf16 v20, v164, v11
  v_dot2c_f32_bf16 v28, v164, v164
  v_dot2c_f32_bf16 v21, v165, v11
  v_dot2c_f32_bf16 v29, v165, v165
  v_dot2c_f32_bf16 v22, v166, v11
  v_dot2c_f32_bf16 v30, v166, v166
  v_dot2c_f32_bf16 v23, v167, v11
  v_dot2c_f32_bf16 v31, v167, v167
  v_dot2c_f32_bf16 v16, v168, v11
  v_dot2c_f32_bf16 v24, v168, v168
  v_dot2c_f32_bf16 v17, v169, v11
  v_dot2c_f32_bf16 v25, v169, v169
  v_dot2c_f32_bf16 v18, v170, v11
  v_dot2c_f32_bf16 v26, v170, v170
  v_dot2c_f32_bf16 v19, v171, v11
  v_dot2c_f32_bf16 v27, v171, v171
  v_dot2c_f32_bf16 v20, v172, v11
  v_dot2c_f32_bf16 v28, v172, v172
  v_dot2c_f32_bf16 v21, v173, v11
  v_dot2c_f32_bf16 v29, v173, v173
  v_dot2c_f32_bf16 v22, v174, v11
  v_dot2c_f32_bf16 v30, v174, v174
  v_dot2c_f32_bf16 v23, v175, v11
  v_dot2c_f32_bf16 v31, v175, v175
  s_barrier
  s_waitcnt vmcnt(12)
  ds_read_b128 v[192:195], v80 offset:16384
  ds_read_b128 v[196:199], v81 offset:16384
  ds_read_b128 v[200:203], v82 offset:16384
  ds_read_b128 v[204:207], v83 offset:16384
  s_waitcnt lgkmcnt(4)
  v_dot2c_f32_bf16 v16, v176, v11
  v_dot2c_f32_bf16 v24, v176, v176
  v_dot2c_f32_bf16 v17, v177, v11
  v_dot2c_f32_bf16 v25, v177, v177
  v_dot2c_f32_bf16 v18, v178, v11
  v_dot2c_f32_bf16 v26, v178, v178
  v_dot2c_f32_bf16 v19, v179, v11
  v_dot2c_f32_bf16 v27, v179, v179
  v_dot2c_f32_bf16 v20, v180, v11
  v_dot2c_f32_bf16 v28, v180, v180
  v_dot2c_f32_bf16 v21, v181, v11
  v_dot2c_f32_bf16 v29, v181, v181
  v_dot2c_f32_bf16 v22, v182, v11
  v_dot2c_f32_bf16 v30, v182, v182
  v_dot2c_f32_bf16 v23, v183, v11
  v_dot2c_f32_bf16 v31, v183, v183
  v_dot2c_f32_bf16 v16, v184, v11
  v_dot2c_f32_bf16 v24, v184, v184
  v_dot2c_f32_bf16 v17, v185, v11
  v_dot2c_f32_bf16 v25, v185, v185
  v_dot2c_f32_bf16 v18, v186, v11
  v_dot2c_f32_bf16 v26, v186, v186
  v_dot2c_f32_bf16 v19, v187, v11
  v_dot2c_f32_bf16 v27, v187, v187
  v_dot2c_f32_bf16 v20, v188, v11
  v_dot2c_f32_bf16 v28, v188, v188
  v_dot2c_f32_bf16 v21, v189, v11
  v_dot2c_f32_bf16 v29, v189, v189
  v_dot2c_f32_bf16 v22, v190, v11
  v_dot2c_f32_bf16 v30, v190, v190
  v_dot2c_f32_bf16 v23, v191, v11
  v_dot2c_f32_bf16 v31, v191, v191
  s_waitcnt vmcnt(8)
  ds_read_b128 v[208:211], v80 offset:20480
  ds_read_b128 v[212:215], v81 offset:20480
  ds_read_b128 v[216:219], v82 offset:20480
  ds_read_b128 v[220:223], v83 offset:20480
  s_waitcnt lgkmcnt(4)
  v_dot2c_f32_bf16 v16, v192, v11
  v_dot2c_f32_bf16 v24, v192, v192
  v_dot2c_f32_bf16 v17, v193, v11
  v_dot2c_f32_bf16 v25, v193, v193
  v_dot2c_f32_bf16 v18, v194, v11
  v_dot2c_f32_bf16 v26, v194, v194
  v_dot2c_f32_bf16 v19, v195, v11
  v_dot2c_f32_bf16 v27, v195, v195
  v_dot2c_f32_bf16 v20, v196, v11
  v_dot2c_f32_bf16 v28, v196, v196
  v_dot2c_f32_bf16 v21, v197, v11
  v_dot2c_f32_bf16 v29, v197, v197
  v_dot2c_f32_bf16 v22, v198, v11
  v_dot2c_f32_bf16 v30, v198, v198
  v_dot2c_f32_bf16 v23, v199, v11
  v_dot2c_f32_bf16 v31, v199, v199
  v_dot2c_f32_bf16 v16, v200, v11
  v_dot2c_f32_bf16 v24, v200, v200
  v_dot2c_f32_bf16 v17, v201, v11
  v_dot2c_f32_bf16 v25, v201, v201
  v_dot2c_f32_bf16 v18, v202, v11
  v_dot2c_f32_bf16 v26, v202, v202
  v_dot2c_f32_bf16 v19, v203, v11
  v_dot2c_f32_bf16 v27, v203, v203
  v_dot2c_f32_bf16 v20, v204, v11
  v_dot2c_f32_bf16 v28, v204, v204
  v_dot2c_f32_bf16 v21, v205, v11
  v_dot2c_f32_bf16 v29, v205, v205
  v_dot2c_f32_bf16 v22, v206, v11
  v_dot2c_f32_bf16 v30, v206, v206
  v_dot2c_f32_bf16 v23, v207, v11
  v_dot2c_f32_bf16 v31, v207, v207
  s_waitcnt vmcnt(4)
  ds_read_b128 v[224:227], v80 offset:24576
  ds_read_b128 v[228:231], v81 offset:24576
  ds_read_b128 v[232:235], v82 offset:24576
  ds_read_b128 v[236:239], v83 offset:24576
  s_waitcnt lgkmcnt(4)
  v_dot2c_f32_bf16 v16, v208, v11
  v_dot2c_f32_bf16 v24, v208, v208
  v_dot2c_f32_bf16 v17, v209, v11
  v_dot2c_f32_bf16 v25, v209, v209
  v_dot2c_f32_bf16 v18, v210, v11
  v_dot2c_f32_bf16 v26, v210, v210
  v_dot2c_f32_bf16 v19, v211, v11
  v_dot2c_f32_bf16 v27, v211, v211
  v_dot2c_f32_bf16 v20, v212, v11
  v_dot2c_f32_bf16 v28, v212, v212
  v_dot2c_f32_bf16 v21, v213, v11
  v_dot2c_f32_bf16 v29, v213, v213
  v_dot2c_f32_bf16 v22, v214, v11
  v_dot2c_f32_bf16 v30, v214, v214
  v_dot2c_f32_bf16 v23, v215, v11
  v_dot2c_f32_bf16 v31, v215, v215
  v_dot2c_f32_bf16 v16, v216, v11
  v_dot2c_f32_bf16 v24, v216, v216
  v_dot2c_f32_bf16 v17, v217, v11
  v_dot2c_f32_bf16 v25, v217, v217
  v_dot2c_f32_bf16 v18, v218, v11
  v_dot2c_f32_bf16 v26, v218, v218
  v_dot2c_f32_bf16 v19, v219, v11
  v_dot2c_f32_bf16 v27, v219, v219
  v_dot2c_f32_bf16 v20, v220, v11
  v_dot2c_f32_bf16 v28, v220, v220
  v_dot2c_f32_bf16 v21, v221, v11
  v_dot2c_f32_bf16 v29, v221, v221
  v_dot2c_f32_bf16 v22, v222, v11
  v_dot2c_f32_bf16 v30, v222, v222
  v_dot2c_f32_bf16 v23, v223, v11
  v_dot2c_f32_bf16 v31, v223, v223
  s_waitcnt vmcnt(0)
  ds_read_b128 v[240:243], v80 offset:28672
  ds_read_b128 v[244:247], v81 offset:28672
  ds_read_b128 v[248:251], v82 offset:28672
  ds_read_b128 v[252:255], v83 offset:28672
  s_waitcnt lgkmcnt(4)
  v_dot2c_f32_bf16 v16, v224, v11
  v_dot2c_f32_bf16 v24, v224, v224
  v_dot2c_f32_bf16 v17, v225, v11
  v_dot2c_f32_bf16 v25, v225, v225
  v_dot2c_f32_bf16 v18, v226, v11
  v_dot2c_f32_bf16 v26, v226, v226
  v_dot2c_f32_bf16 v19, v227, v11
  v_dot2c_f32_bf16 v27, v227, v227
  v_dot2c_f32_bf16 v20, v228, v11
  v_dot2c_f32_bf16 v28, v228, v228
  v_dot2c_f32_bf16 v21, v229, v11
  v_dot2c_f32_bf16 v29, v229, v229
  v_dot2c_f32_bf16 v22, v230, v11
  v_dot2c_f32_bf16 v30, v230, v230
  v_dot2c_f32_bf16 v23, v231, v11
  v_dot2c_f32_bf16 v31, v231, v231
  v_dot2c_f32_bf16 v16, v232, v11
  v_dot2c_f32_bf16 v24, v232, v232
  v_dot2c_f32_bf16 v17, v233, v11
  v_dot2c_f32_bf16 v25, v233, v233
  v_dot2c_f32_bf16 v18, v234, v11
  v_dot2c_f32_bf16 v26, v234, v234
  v_dot2c_f32_bf16 v19, v235, v11
  v_dot2c_f32_bf16 v27, v235, v235
  v_dot2c_f32_bf16 v20, v236, v11
  v_dot2c_f32_bf16 v28, v236, v236
  v_dot2c_f32_bf16 v21, v237, v11
  v_dot2c_f32_bf16 v29, v237, v237
  v_dot2c_f32_bf16 v22, v238, v11
  v_dot2c_f32_bf16 v30, v238, v238
  v_dot2c_f32_bf16 v23, v239, v11
  v_dot2c_f32_bf16 v31, v239, v239
  s_waitcnt lgkmcnt(0)
  v_dot2c_f32_bf16 v16, v240, v11
  v_dot2c_f32_bf16 v24, v240, v240
  v_dot2c_f32_bf16 v17, v241, v11
  v_dot2c_f32_bf16 v25, v241, v241
  v_dot2c_f32_bf16 v18, v242, v11
  v_dot2c_f32_bf16 v26, v242, v242
  v_dot2c_f32_bf16 v19, v243, v11
  v_dot2c_f32_bf16 v27, v243, v243
  v_dot2c_f32_bf16 v20, v244, v11
  v_dot2c_f32_bf16 v28, v244, v244
  v_dot2c_f32_bf16 v21, v245, v11
  v_dot2c_f32_bf16 v29, v245, v245
  v_dot2c_f32_bf16 v22, v246, v11
  v_dot2c_f32_bf16 v30, v246, v246
  v_dot2c_f32_bf16 v23, v247, v11
  v_dot2c_f32_bf16 v31, v247, v247
  v_dot2c_f32_bf16 v16, v248, v11
  v_dot2c_f32_bf16 v24, v248, v248
  v_dot2c_f32_bf16 v17, v249, v11
  v_dot2c_f32_bf16 v25, v249, v249
  v_dot2c_f32_bf16 v18, v250, v11
  v_dot2c_f32_bf16 v26, v250, v250
  v_dot2c_f32_bf16 v19, v251, v11
  v_dot2c_f32_bf16 v27, v251, v251
  v_dot2c_f32_bf16 v20, v252, v11
  v_dot2c_f32_bf16 v28, v252, v252
  v_dot2c_f32_bf16 v21, v253, v11
  v_dot2c_f32_bf16 v29, v253, v253
  v_dot2c_f32_bf16 v22, v254, v11
  v_dot2c_f32_bf16 v30, v254, v254
  v_dot2c_f32_bf16 v23, v255, v11
  v_dot2c_f32_bf16 v31, v255, v255
  s_barrier
  s_nop 1
  v_add_f32 v16, v16, v20
  v_add_f32 v24, v24, v28
  v_add_f32 v17, v17, v21
  v_add_f32 v25, v25, v29
  v_add_f32 v18, v18, v22
  v_add_f32 v26, v26, v30
  v_add_f32 v19, v19, v23
  v_add_f32 v27, v27, v31
  v_add_f32 v16, v16, v18
  v_add_f32 v24, v24, v26
  v_add_f32 v17, v17, v19
  v_add_f32 v25, v25, v27
  v_add_f32 v16, v16, v17
  v_add_f32 v24, v24, v25
  v_mov_b32 v17, v16
  v_mov_b32 v25, v24
  s_nop 1
  v_permlane32_swap_b32 v16, v17
  v_permlane32_swap_b32 v24, v25
  s_nop 1
  v_add_f32 v16, v16, v17
  v_add_f32 v24, v24, v25
  v_mul_f32 v16, 0x3b000000, v16
  v_mul_f32 v24, 0x3b000000, v24
  v_cvt_pk_bf16_f32 v17, v16, v16
  v_fma_f32 v8, -v16, v16, v24
  v_lshlrev_b32 v17, 16, v17
  v_max_f32 v8, 0, v8
  v_sub_f32 v48, 0, v17
  v_sub_f32 v49, 0, v17
  v_sub_f32 v50, 0, v17
  v_sub_f32 v51, 0, v17
  v_sub_f32 v52, 0, v17
  v_sub_f32 v53, 0, v17
  v_sub_f32 v54, 0, v17
  v_sub_f32 v55, 0, v17
  v_sub_f32 v56, 0, v17
  v_sub_f32 v57, 0, v17
  v_sub_f32 v58, 0, v17
  v_sub_f32 v59, 0, v17
  v_sub_f32 v60, 0, v17
  v_sub_f32 v61, 0, v17
  v_sub_f32 v62, 0, v17
  v_sub_f32 v63, 0, v17
  v_cvt_pk_bf16_f32 v8, v8, v8
  v_lshlrev_b32 v8, 16, v8
  v_mfma_f32_32x32x16_bf16 v[16:31], v[108:111], v[128:131], v[48:63]
  v_add_f32 v8, 0x3727c5ac, v8
  v_cvt_pk_bf16_f32 v8, v8, v8
  v_lshlrev_b32 v8, 16, v8
  v_sqrt_f32 v8, v8
  v_mfma_f32_32x32x16_bf16 v[32:47], v[108:111], v[132:135], v[48:63]
  v_cvt_pk_bf16_f32 v9, v8, v8
  v_and_b32 v9, 0xffff, v9
  v_lshlrev_b32 v8, 16, v9
  v_rcp_f32 v5, v8
  v_mfma_f32_32x32x16_bf16 v[64:79], v[108:111], v[136:139], v[48:63]
  v_bfe_u32 v10, v0, 5, 1
  v_cmp_eq_u32 vcc, 0, v10
  s_nop 1
  v_cndmask_b32 v104, 0, v9, vcc
  v_mfma_f32_32x32x16_bf16 v[80:95], v[108:111], v[140:143], v[48:63]
  v_cvt_pk_bf16_f32 v128, v16, v17
  v_cvt_pk_bf16_f32 v129, v18, v19
  v_cvt_pk_bf16_f32 v130, v20, v21
  v_cvt_pk_bf16_f32 v131, v22, v23
  v_mfma_f32_32x32x16_bf16 v[16:31], v[108:111], v[144:147], v[48:63]
  v_cvt_pk_bf16_f32 v132, v32, v33
  v_cvt_pk_bf16_f32 v133, v34, v35
  v_cvt_pk_bf16_f32 v134, v36, v37
  v_cvt_pk_bf16_f32 v135, v38, v39
  v_mfma_f32_32x32x16_bf16 v[32:47], v[108:111], v[148:151], v[48:63]
  v_cvt_pk_bf16_f32 v136, v64, v65
  v_cvt_pk_bf16_f32 v137, v66, v67
  v_cvt_pk_bf16_f32 v138, v68, v69
  v_cvt_pk_bf16_f32 v139, v70, v71
  v_mfma_f32_32x32x16_bf16 v[64:79], v[108:111], v[152:155], v[48:63]
  v_cvt_pk_bf16_f32 v140, v80, v81
  v_cvt_pk_bf16_f32 v141, v82, v83
  v_cvt_pk_bf16_f32 v142, v84, v85
  v_cvt_pk_bf16_f32 v143, v86, v87
  v_mfma_f32_32x32x16_bf16 v[80:95], v[108:111], v[156:159], v[48:63]
  v_cvt_pk_bf16_f32 v144, v16, v17
  v_cvt_pk_bf16_f32 v145, v18, v19
  v_cvt_pk_bf16_f32 v146, v20, v21
  v_cvt_pk_bf16_f32 v147, v22, v23
  v_mfma_f32_32x32x16_bf16 v[16:31], v[108:111], v[160:163], v[48:63]
  v_cvt_pk_bf16_f32 v148, v32, v33
  v_cvt_pk_bf16_f32 v149, v34, v35
  v_cvt_pk_bf16_f32 v150, v36, v37
  v_cvt_pk_bf16_f32 v151, v38, v39
  v_mfma_f32_32x32x16_bf16 v[32:47], v[108:111], v[164:167], v[48:63]
  v_cvt_pk_bf16_f32 v152, v64, v65
  v_cvt_pk_bf16_f32 v153, v66, v67
  v_cvt_pk_bf16_f32 v154, v68, v69
  v_cvt_pk_bf16_f32 v155, v70, v71
  v_mfma_f32_32x32x16_bf16 v[64:79], v[108:111], v[168:171], v[48:63]
  v_cvt_pk_bf16_f32 v156, v80, v81
  v_cvt_pk_bf16_f32 v157, v82, v83
  v_cvt_pk_bf16_f32 v158, v84, v85
  v_cvt_pk_bf16_f32 v159, v86, v87
  v_mfma_f32_32x32x16_bf16 v[80:95], v[108:111], v[172:175], v[48:63]
  v_cvt_pk_bf16_f32 v160, v16, v17
  v_cvt_pk_bf16_f32 v161, v18, v19
  v_cvt_pk_bf16_f32 v162, v20, v21
  v_cvt_pk_bf16_f32 v163, v22, v23
  v_mfma_f32_32x32x16_bf16 v[16:31], v[108:111], v[176:179], v[48:63]
  v_cvt_pk_bf16_f32 v164, v32, v33
  v_cvt_pk_bf16_f32 v165, v34, v35
  v_cvt_pk_bf16_f32 v166, v36, v37
  v_cvt_pk_bf16_f32 v167, v38, v39
  v_mfma_f32_32x32x16_bf16 v[32:47], v[108:111], v[180:183], v[48:63]
  v_cvt_pk_bf16_f32 v168, v64, v65
  v_cvt_pk_bf16_f32 v169, v66, v67
  v_cvt_pk_bf16_f32 v170, v68, v69
  v_cvt_pk_bf16_f32 v171, v70, v71
  v_mfma_f32_32x32x16_bf16 v[64:79], v[108:111], v[184:187], v[48:63]
  v_cvt_pk_bf16_f32 v172, v80, v81
  v_cvt_pk_bf16_f32 v173, v82, v83
  v_cvt_pk_bf16_f32 v174, v84, v85
  v_cvt_pk_bf16_f32 v175, v86, v87
  v_mfma_f32_32x32x16_bf16 v[80:95], v[108:111], v[188:191], v[48:63]
  v_cvt_pk_bf16_f32 v176, v16, v17
  v_cvt_pk_bf16_f32 v177, v18, v19
  v_cvt_pk_bf16_f32 v178, v20, v21
  v_cvt_pk_bf16_f32 v179, v22, v23
  v_mfma_f32_32x32x16_bf16 v[16:31], v[108:111], v[192:195], v[48:63]
  v_cvt_pk_bf16_f32 v180, v32, v33
  v_cvt_pk_bf16_f32 v181, v34, v35
  v_cvt_pk_bf16_f32 v182, v36, v37
  v_cvt_pk_bf16_f32 v183, v38, v39
  v_mfma_f32_32x32x16_bf16 v[32:47], v[108:111], v[196:199], v[48:63]
  v_cvt_pk_bf16_f32 v184, v64, v65
  v_cvt_pk_bf16_f32 v185, v66, v67
  v_cvt_pk_bf16_f32 v186, v68, v69
  v_cvt_pk_bf16_f32 v187, v70, v71
  v_mfma_f32_32x32x16_bf16 v[64:79], v[108:111], v[200:203], v[48:63]
  v_cvt_pk_bf16_f32 v188, v80, v81
  v_cvt_pk_bf16_f32 v189, v82, v83
  v_cvt_pk_bf16_f32 v190, v84, v85
  v_cvt_pk_bf16_f32 v191, v86, v87
  v_mfma_f32_32x32x16_bf16 v[80:95], v[108:111], v[204:207], v[48:63]
  v_cvt_pk_bf16_f32 v192, v16, v17
  v_cvt_pk_bf16_f32 v193, v18, v19
  v_cvt_pk_bf16_f32 v194, v20, v21
  v_cvt_pk_bf16_f32 v195, v22, v23
  v_mfma_f32_32x32x16_bf16 v[16:31], v[108:111], v[208:211], v[48:63]
  v_cvt_pk_bf16_f32 v196, v32, v33
  v_cvt_pk_bf16_f32 v197, v34, v35
  v_cvt_pk_bf16_f32 v198, v36, v37
  v_cvt_pk_bf16_f32 v199, v38, v39
  v_mfma_f32_32x32x16_bf16 v[32:47], v[108:111], v[212:215], v[48:63]
  v_cvt_pk_bf16_f32 v200, v64, v65
  v_cvt_pk_bf16_f32 v201, v66, v67
  v_cvt_pk_bf16_f32 v202, v68, v69
  v_cvt_pk_bf16_f32 v203, v70, v71
  v_mfma_f32_32x32x16_bf16 v[64:79], v[108:111], v[216:219], v[48:63]
  v_cvt_pk_bf16_f32 v204, v80, v81
  v_cvt_pk_bf16_f32 v205, v82, v83
  v_cvt_pk_bf16_f32 v206, v84, v85
  v_cvt_pk_bf16_f32 v207, v86, v87
  v_mfma_f32_32x32x16_bf16 v[80:95], v[108:111], v[220:223], v[48:63]
  v_cvt_pk_bf16_f32 v208, v16, v17
  v_cvt_pk_bf16_f32 v209, v18, v19
  v_cvt_pk_bf16_f32 v210, v20, v21
  v_cvt_pk_bf16_f32 v211, v22, v23
  v_mfma_f32_32x32x16_bf16 v[16:31], v[108:111], v[224:227], v[48:63]
  v_cvt_pk_bf16_f32 v212, v32, v33
  v_cvt_pk_bf16_f32 v213, v34, v35
  v_cvt_pk_bf16_f32 v214, v36, v37
  v_cvt_pk_bf16_f32 v215, v38, v39
  v_mfma_f32_32x32x16_bf16 v[32:47], v[108:111], v[228:231], v[48:63]
  v_cvt_pk_bf16_f32 v216, v64, v65
  v_cvt_pk_bf16_f32 v217, v66, v67
  v_cvt_pk_bf16_f32 v218, v68, v69
  v_cvt_pk_bf16_f32 v219, v70, v71
  v_mfma_f32_32x32x16_bf16 v[64:79], v[108:111], v[232:235], v[48:63]
  v_cvt_pk_bf16_f32 v220, v80, v81
  v_cvt_pk_bf16_f32 v221, v82, v83
  v_cvt_pk_bf16_f32 v222, v84, v85
  v_cvt_pk_bf16_f32 v223, v86, v87
  v_mfma_f32_32x32x16_bf16 v[80:95], v[108:111], v[236:239], v[48:63]
  v_cvt_pk_bf16_f32 v224, v16, v17
  v_cvt_pk_bf16_f32 v225, v18, v19
  v_cvt_pk_bf16_f32 v226, v20, v21
  v_cvt_pk_bf16_f32 v227, v22, v23
  v_mfma_f32_32x32x16_bf16 v[16:31], v[108:111], v[240:243], v[48:63]
  v_cvt_pk_bf16_f32 v228, v32, v33
  v_cvt_pk_bf16_f32 v229, v34, v35
  v_cvt_pk_bf16_f32 v230, v36, v37
  v_cvt_pk_bf16_f32 v231, v38, v39
  v_mfma_f32_32x32x16_bf16 v[32:47], v[108:111], v[244:247], v[48:63]
  v_cvt_pk_bf16_f32 v232, v64, v65
  v_cvt_pk_bf16_f32 v233, v66, v67
  v_cvt_pk_bf16_f32 v234, v68, v69
  v_cvt_pk_bf16_f32 v235, v70, v71
  v_mfma_f32_32x32x16_bf16 v[64:79], v[108:111], v[248:251], v[48:63]
  v_cvt_pk_bf16_f32 v236, v80, v81
  v_cvt_pk_bf16_f32 v237, v82, v83
  v_cvt_pk_bf16_f32 v238, v84, v85
  v_cvt_pk_bf16_f32 v239, v86, v87
  v_mfma_f32_32x32x16_bf16 v[80:95], v[108:111], v[252:255], v[48:63]
  v_cvt_pk_bf16_f32 v240, v16, v17
  v_cvt_pk_bf16_f32 v241, v18, v19
  v_cvt_pk_bf16_f32 v242, v20, v21
  v_cvt_pk_bf16_f32 v243, v22, v23
  s_nop 3
  v_cvt_pk_bf16_f32 v244, v32, v33
  v_cvt_pk_bf16_f32 v245, v34, v35
  v_cvt_pk_bf16_f32 v246, v36, v37
  v_cvt_pk_bf16_f32 v247, v38, v39
  s_nop 3
  v_cvt_pk_bf16_f32 v248, v64, v65
  v_cvt_pk_bf16_f32 v249, v66, v67
  v_cvt_pk_bf16_f32 v250, v68, v69
  v_cvt_pk_bf16_f32 v251, v70, v71
  s_nop 3
  v_cvt_pk_bf16_f32 v252, v80, v81
  v_cvt_pk_bf16_f32 v253, v82, v83
  v_cvt_pk_bf16_f32 v254, v84, v85
  v_cvt_pk_bf16_f32 v255, v86, v87
  s_mov_b32 s38, 0
  s_mov_b32 s39, s35
  s_mov_b32 s40, 0x7ff00000
  s_cmp_lt_u32 s34, 10
  s_cbranch_scc1 lnqkv_kernel_F
  s_cmp_lt_u32 s34, 14
  s_cbranch_scc1 lnqkv_kernel_QK
  s_branch lnqkv_kernel_V
lnqkv_kernel_F:
  v_mul_f32 v5, 0x3fb8aa3b, v5
  v_mov_b32 v7, 0xbfb17218
  v_mov_b32 v4, v1
  v_and_b32 v6, 31, v0
  v_lshlrev_b32 v6, 1, v6
  s_mov_b32 s20, s58
  s_and_b32 s21, s59, 0xffff
  s_mov_b32 s22, 0xe00
  s_mov_b32 s23, 0x00020000
  s_mul_i32 s3, s37, 144
  s_lshl_b32 s4, s35, 1
  s_add_u32 s3, s3, s4
  s_add_u32 s3, s3, 32
  s_lshl_b32 s3, s3, 10
  s_add_u32 s41, s3, 8388608
  s_movk_i32 s46, 2048
  s_barrier
  ds_read_b64_tr_b16 v[48:49], v2 offset:0
  ds_read_b64_tr_b16 v[50:51], v2 offset:1024
  ds_read_b64_tr_b16 v[52:53], v2 offset:2048
  ds_read_b64_tr_b16 v[54:55], v2 offset:3072
  ds_read_b64_tr_b16 v[56:57], v2 offset:4096
  ds_read_b64_tr_b16 v[58:59], v2 offset:5120
  ds_read_b64_tr_b16 v[60:61], v2 offset:6144
  ds_read_b64_tr_b16 v[62:63], v2 offset:7168
lnqkv_kernel_F_loop:
  s_waitcnt lgkmcnt(4)
  v_mfma_f32_32x32x16_bf16 v[16:31], v[48:51], v[128:131], 0
  ds_read_b64_tr_b16 v[64:65], v2 offset:8192
  ds_read_b64_tr_b16 v[66:67], v2 offset:9216
  s_lshl_b32 s4, s39, 6
  buffer_load_ushort v100, v6, s[20:23], s4 offen
  s_add_u32 s38, s38, 1
  s_bitcmp1_b32 s39, 0
  s_cselect_b32 s3, 0x10040, 64
  v_mfma_f32_32x32x16_bf16 v[16:31], v[52:55], v[132:135], v[16:31]
  ds_read_b64_tr_b16 v[68:69], v2 offset:10240
  ds_read_b64_tr_b16 v[70:71], v2 offset:11264
  s_cselect_b32 s42, 1, 0
  v_xor_b32 v3, s3, v2
  s_cmp_lt_u32 s38, s36
  s_cselect_b32 s42, s42, 0
  s_waitcnt lgkmcnt(4)
  v_mfma_f32_32x32x16_bf16 v[16:31], v[56:59], v[136:139], v[16:31]
  ds_read_b64_tr_b16 v[72:73], v2 offset:12288
  ds_read_b64_tr_b16 v[74:75], v2 offset:13312
  v_mfma_f32_32x32x16_bf16 v[16:31], v[60:63], v[140:143], v[16:31]
  ds_read_b64_tr_b16 v[76:77], v2 offset:14336
  ds_read_b64_tr_b16 v[78:79], v2 offset:15360
  v_mul_f32 v80, v32, v5
  v_mul_f32 v81, v33, v5
  v_mul_f32 v82, v34, v5
  v_mul_f32 v83, v35, v5
  v_exp_f32 v84, v80
  s_waitcnt lgkmcnt(4)
  v_mfma_f32_32x32x16_bf16 v[16:31], v[64:67], v[144:147], v[16:31]
  ds_read_b64_tr_b16 v[48:49], v2 offset:16384
  ds_read_b64_tr_b16 v[50:51], v2 offset:17408
  v_exp_f32 v85, v81
  v_exp_f32 v86, v82
  v_exp_f32 v87, v83
  v_add_f32 v84, 1.0, v84
  v_add_f32 v85, 1.0, v85
  v_mfma_f32_32x32x16_bf16 v[16:31], v[68:71], v[148:151], v[16:31]
  ds_read_b64_tr_b16 v[52:53], v2 offset:18432
  ds_read_b64_tr_b16 v[54:55], v2 offset:19456
  v_add_f32 v86, 1.0, v86
  v_add_f32 v87, 1.0, v87
  v_fma_f32 v88, v84, v84, 1.0
  v_fma_f32 v89, v85, v85, 1.0
  v_fma_f32 v90, v86, v86, 1.0
  s_waitcnt lgkmcnt(4)
  v_mfma_f32_32x32x16_bf16 v[16:31], v[72:75], v[152:155], v[16:31]
  ds_read_b64_tr_b16 v[56:57], v2 offset:20480
  ds_read_b64_tr_b16 v[58:59], v2 offset:21504
  v_fma_f32 v91, v87, v87, 1.0
  v_rcp_f32 v88, v88
  v_rcp_f32 v89, v89
  v_rcp_f32 v90, v90
  v_mfma_f32_32x32x16_bf16 v[16:31], v[76:79], v[156:159], v[16:31]
  ds_read_b64_tr_b16 v[60:61], v2 offset:22528
  ds_read_b64_tr_b16 v[62:63], v2 offset:23552
  v_rcp_f32 v91, v91
  v_fmaak_f32 v88, v88, v7, 0x3f317218
  v_fmaak_f32 v89, v89, v7, 0x3f317218
  v_fmaak_f32 v90, v90, v7, 0x3f317218
  v_fmaak_f32 v91, v91, v7, 0x3f317218
  s_waitcnt lgkmcnt(4)
  v_mfma_f32_32x32x16_bf16 v[16:31], v[48:51], v[160:163], v[16:31]
  ds_read_b64_tr_b16 v[64:65], v2 offset:24576
  ds_read_b64_tr_b16 v[66:67], v2 offset:25600
  v_mul_f32 v80, v80, v88
  v_mul_f32 v81, v81, v89
  v_mul_f32 v82, v82, v90
  v_mul_f32 v83, v83, v91
  v_cvt_pk_bf16_f32 v92, v80, v81
  v_mfma_f32_32x32x16_bf16 v[16:31], v[52:55], v[164:167], v[16:31]
  ds_read_b64_tr_b16 v[68:69], v2 offset:26624
  ds_read_b64_tr_b16 v[70:71], v2 offset:27648
  v_cvt_pk_bf16_f32 v93, v82, v83
  v_mul_f32 v80, v36, v5
  v_mul_f32 v81, v37, v5
  v_mul_f32 v82, v38, v5
  s_waitcnt lgkmcnt(4)
  v_mfma_f32_32x32x16_bf16 v[16:31], v[56:59], v[168:171], v[16:31]
  ds_read_b64_tr_b16 v[72:73], v2 offset:28672
  ds_read_b64_tr_b16 v[74:75], v2 offset:29696
  v_mul_f32 v83, v39, v5
  v_exp_f32 v84, v80
  v_exp_f32 v85, v81
  v_exp_f32 v86, v82
  v_exp_f32 v87, v83
  v_mfma_f32_32x32x16_bf16 v[16:31], v[60:63], v[172:175], v[16:31]
  ds_read_b64_tr_b16 v[76:77], v2 offset:30720
  ds_read_b64_tr_b16 v[78:79], v2 offset:31744
  v_add_f32 v84, 1.0, v84
  v_add_f32 v85, 1.0, v85
  v_add_f32 v86, 1.0, v86
  v_add_f32 v87, 1.0, v87
  v_fma_f32 v88, v84, v84, 1.0
  s_waitcnt lgkmcnt(4)
  v_mfma_f32_32x32x16_bf16 v[16:31], v[64:67], v[176:179], v[16:31]
  ds_read_b64_tr_b16 v[48:49], v2 offset:32768
  ds_read_b64_tr_b16 v[50:51], v2 offset:33792
  v_fma_f32 v89, v85, v85, 1.0
  v_fma_f32 v90, v86, v86, 1.0
  v_fma_f32 v91, v87, v87, 1.0
  v_rcp_f32 v88, v88
  v_mfma_f32_32x32x16_bf16 v[16:31], v[68:71], v[180:183], v[16:31]
  ds_read_b64_tr_b16 v[52:53], v2 offset:34816
  ds_read_b64_tr_b16 v[54:55], v2 offset:35840
  v_rcp_f32 v89, v89
  v_rcp_f32 v90, v90
  v_rcp_f32 v91, v91
  v_fmaak_f32 v88, v88, v7, 0x3f317218
  v_fmaak_f32 v89, v89, v7, 0x3f317218
  s_waitcnt lgkmcnt(4)
  v_mfma_f32_32x32x16_bf16 v[16:31], v[72:75], v[184:187], v[16:31]
  ds_read_b64_tr_b16 v[56:57], v2 offset:36864
  ds_read_b64_tr_b16 v[58:59], v2 offset:37888
  v_fmaak_f32 v90, v90, v7, 0x3f317218
  v_fmaak_f32 v91, v91, v7, 0x3f317218
  v_mul_f32 v80, v80, v88
  v_mul_f32 v81, v81, v89
  v_mul_f32 v82, v82, v90
  v_mfma_f32_32x32x16_bf16 v[16:31], v[76:79], v[188:191], v[16:31]
  ds_read_b64_tr_b16 v[60:61], v2 offset:38912
  ds_read_b64_tr_b16 v[62:63], v2 offset:39936
  v_mul_f32 v83, v83, v91
  v_cvt_pk_bf16_f32 v94, v80, v81
  v_cvt_pk_bf16_f32 v95, v82, v83
  buffer_store_dwordx4 v[92:95], v4, s[16:19], s40 offen sc1
  s_waitcnt lgkmcnt(4)
  v_mfma_f32_32x32x16_bf16 v[16:31], v[48:51], v[192:195], v[16:31]
  ds_read_b64_tr_b16 v[64:65], v2 offset:40960
  ds_read_b64_tr_b16 v[66:67], v2 offset:41984
  v_mul_f32 v80, v40, v5
  v_mul_f32 v81, v41, v5
  v_mul_f32 v82, v42, v5
  v_mul_f32 v83, v43, v5
  v_exp_f32 v84, v80
  v_mfma_f32_32x32x16_bf16 v[16:31], v[52:55], v[196:199], v[16:31]
  ds_read_b64_tr_b16 v[68:69], v2 offset:43008
  ds_read_b64_tr_b16 v[70:71], v2 offset:44032
  v_exp_f32 v85, v81
  v_exp_f32 v86, v82
  v_exp_f32 v87, v83
  v_add_f32 v84, 1.0, v84
  v_add_f32 v85, 1.0, v85
  s_waitcnt lgkmcnt(4)
  v_mfma_f32_32x32x16_bf16 v[16:31], v[56:59], v[200:203], v[16:31]
  ds_read_b64_tr_b16 v[72:73], v2 offset:45056
  ds_read_b64_tr_b16 v[74:75], v2 offset:46080
  v_add_f32 v86, 1.0, v86
  v_add_f32 v87, 1.0, v87
  v_fma_f32 v88, v84, v84, 1.0
  v_fma_f32 v89, v85, v85, 1.0
  v_fma_f32 v90, v86, v86, 1.0
  v_mfma_f32_32x32x16_bf16 v[16:31], v[60:63], v[204:207], v[16:31]
  ds_read_b64_tr_b16 v[76:77], v2 offset:47104
  ds_read_b64_tr_b16 v[78:79], v2 offset:48128
  v_fma_f32 v91, v87, v87, 1.0
  v_rcp_f32 v88, v88
  v_rcp_f32 v89, v89
  v_rcp_f32 v90, v90
  s_waitcnt lgkmcnt(4)
  v_mfma_f32_32x32x16_bf16 v[16:31], v[64:67], v[208:211], v[16:31]
  ds_read_b64_tr_b16 v[48:49], v2 offset:49152
  ds_read_b64_tr_b16 v[50:51], v2 offset:50176
  v_rcp_f32 v91, v91
  v_fmaak_f32 v88, v88, v7, 0x3f317218
  v_fmaak_f32 v89, v89, v7, 0x3f317218
  v_fmaak_f32 v90, v90, v7, 0x3f317218
  v_fmaak_f32 v91, v91, v7, 0x3f317218
  v_mfma_f32_32x32x16_bf16 v[16:31], v[68:71], v[212:215], v[16:31]
  ds_read_b64_tr_b16 v[52:53], v2 offset:51200
  ds_read_b64_tr_b16 v[54:55], v2 offset:52224
  v_mul_f32 v80, v80, v88
  v_mul_f32 v81, v81, v89
  v_mul_f32 v82, v82, v90
  v_mul_f32 v83, v83, v91
  v_cvt_pk_bf16_f32 v96, v80, v81
  s_waitcnt lgkmcnt(4)
  v_mfma_f32_32x32x16_bf16 v[16:31], v[72:75], v[216:219], v[16:31]
  ds_read_b64_tr_b16 v[56:57], v2 offset:53248
  ds_read_b64_tr_b16 v[58:59], v2 offset:54272
  v_cvt_pk_bf16_f32 v97, v82, v83
  v_mul_f32 v80, v44, v5
  v_mul_f32 v81, v45, v5
  v_mul_f32 v82, v46, v5
  v_mfma_f32_32x32x16_bf16 v[16:31], v[76:79], v[220:223], v[16:31]
  ds_read_b64_tr_b16 v[60:61], v2 offset:55296
  ds_read_b64_tr_b16 v[62:63], v2 offset:56320
  v_mul_f32 v83, v47, v5
  v_exp_f32 v84, v80
  v_exp_f32 v85, v81
  v_exp_f32 v86, v82
  v_exp_f32 v87, v83
  s_waitcnt lgkmcnt(4)
  v_mfma_f32_32x32x16_bf16 v[16:31], v[48:51], v[224:227], v[16:31]
  ds_read_b64_tr_b16 v[64:65], v2 offset:57344
  ds_read_b64_tr_b16 v[66:67], v2 offset:58368
  v_add_f32 v84, 1.0, v84
  v_add_f32 v85, 1.0, v85
  v_add_f32 v86, 1.0, v86
  v_add_f32 v87, 1.0, v87
  v_fma_f32 v88, v84, v84, 1.0
  v_mfma_f32_32x32x16_bf16 v[16:31], v[52:55], v[228:231], v[16:31]
  ds_read_b64_tr_b16 v[68:69], v2 offset:59392
  ds_read_b64_tr_b16 v[70:71], v2 offset:60416
  v_fma_f32 v89, v85, v85, 1.0
  v_fma_f32 v90, v86, v86, 1.0
  v_fma_f32 v91, v87, v87, 1.0
  v_rcp_f32 v88, v88
  s_waitcnt lgkmcnt(4)
  v_mfma_f32_32x32x16_bf16 v[16:31], v[56:59], v[232:235], v[16:31]
  ds_read_b64_tr_b16 v[72:73], v2 offset:61440
  ds_read_b64_tr_b16 v[74:75], v2 offset:62464
  v_rcp_f32 v89, v89
  v_rcp_f32 v90, v90
  v_rcp_f32 v91, v91
  v_fmaak_f32 v88, v88, v7, 0x3f317218
  v_fmaak_f32 v89, v89, v7, 0x3f317218
  v_mfma_f32_32x32x16_bf16 v[16:31], v[60:63], v[236:239], v[16:31]
  ds_read_b64_tr_b16 v[76:77], v2 offset:63488
  ds_read_b64_tr_b16 v[78:79], v2 offset:64512
  v_fmaak_f32 v90, v90, v7, 0x3f317218
  v_fmaak_f32 v91, v91, v7, 0x3f317218
  v_mul_f32 v80, v80, v88
  v_mul_f32 v81, v81, v89
  v_mul_f32 v82, v82, v90
  s_waitcnt lgkmcnt(4)
  v_mfma_f32_32x32x16_bf16 v[16:31], v[64:67], v[240:243], v[16:31]
  v_mul_f32 v83, v83, v91
  v_cvt_pk_bf16_f32 v98, v80, v81
  v_cvt_pk_bf16_f32 v99, v82, v83
  buffer_store_dwordx4 v[96:99], v4, s[16:19], s40 offen offset:1024 sc1
  v_mfma_f32_32x32x16_bf16 v[16:31], v[68:71], v[244:247], v[16:31]
  s_mov_b32 s40, s41
  s_add_u32 s41, s41, s46
  s_add_u32 s39, s39, 1
  s_waitcnt lgkmcnt(0)
  s_cmp_eq_u32 s42, 0
  v_mfma_f32_32x32x16_bf16 v[16:31], v[72:75], v[248:251], v[16:31]
  s_cbranch_scc1 lnqkv_kernel_F_nb
  s_barrier
lnqkv_kernel_F_nb:
  ds_read_b64_tr_b16 v[48:49], v3 offset:0
  ds_read_b64_tr_b16 v[50:51], v3 offset:1024
  ds_read_b64_tr_b16 v[52:53], v3 offset:2048
  ds_read_b64_tr_b16 v[54:55], v3 offset:3072
  v_mfma_f32_32x32x16_bf16 v[16:31], v[76:79], v[252:255], v[16:31]
  s_waitcnt vmcnt(2)
  v_mfma_f32_32x32x16_bf16 v[32:47], v[100:103], v[104:107], v[16:31]
  ds_read_b64_tr_b16 v[56:57], v3 offset:4096
  ds_read_b64_tr_b16 v[58:59], v3 offset:5120
  ds_read_b64_tr_b16 v[60:61], v3 offset:6144
  ds_read_b64_tr_b16 v[62:63], v3 offset:7168
  v_mov_b32 v2, v3
  s_cmp_lt_u32 s38, s36
  s_cbranch_scc1 lnqkv_kernel_F_loop
  s_nop 9
  v_mul_f32 v80, v32, v5
  v_mul_f32 v81, v33, v5
  v_mul_f32 v82, v34, v5
  v_mul_f32 v83, v35, v5
  v_exp_f32 v84, v80
  v_exp_f32 v85, v81
  v_exp_f32 v86, v82
  v_exp_f32 v87, v83
  v_add_f32 v84, 1.0, v84
  v_add_f32 v85, 1.0, v85
  v_add_f32 v86, 1.0, v86
  v_add_f32 v87, 1.0, v87
  v_fma_f32 v88, v84, v84, 1.0
  v_fma_f32 v89, v85, v85, 1.0
  v_fma_f32 v90, v86, v86, 1.0
  v_fma_f32 v91, v87, v87, 1.0
  v_rcp_f32 v88, v88
  v_rcp_f32 v89, v89
  v_rcp_f32 v90, v90
  v_rcp_f32 v91, v91
  v_fmaak_f32 v88, v88, v7, 0x3f317218
  v_fmaak_f32 v89, v89, v7, 0x3f317218
  v_fmaak_f32 v90, v90, v7, 0x3f317218
  v_fmaak_f32 v91, v91, v7, 0x3f317218
  v_mul_f32 v80, v80, v88
  v_mul_f32 v81, v81, v89
  v_mul_f32 v82, v82, v90
  v_mul_f32 v83, v83, v91
  v_cvt_pk_bf16_f32 v92, v80, v81
  v_cvt_pk_bf16_f32 v93, v82, v83
  v_mul_f32 v80, v36, v5
  v_mul_f32 v81, v37, v5
  v_mul_f32 v82, v38, v5
  v_mul_f32 v83, v39, v5
  v_exp_f32 v84, v80
  v_exp_f32 v85, v81
  v_exp_f32 v86, v82
  v_exp_f32 v87, v83
  v_add_f32 v84, 1.0, v84
  v_add_f32 v85, 1.0, v85
  v_add_f32 v86, 1.0, v86
  v_add_f32 v87, 1.0, v87
  v_fma_f32 v88, v84, v84, 1.0
  v_fma_f32 v89, v85, v85, 1.0
  v_fma_f32 v90, v86, v86, 1.0
  v_fma_f32 v91, v87, v87, 1.0
  v_rcp_f32 v88, v88
  v_rcp_f32 v89, v89
  v_rcp_f32 v90, v90
  v_rcp_f32 v91, v91
  v_fmaak_f32 v88, v88, v7, 0x3f317218
  v_fmaak_f32 v89, v89, v7, 0x3f317218
  v_fmaak_f32 v90, v90, v7, 0x3f317218
  v_fmaak_f32 v91, v91, v7, 0x3f317218
  v_mul_f32 v80, v80, v88
  v_mul_f32 v81, v81, v89
  v_mul_f32 v82, v82, v90
  v_mul_f32 v83, v83, v91
  v_cvt_pk_bf16_f32 v94, v80, v81
  v_cvt_pk_bf16_f32 v95, v82, v83
  buffer_store_dwordx4 v[92:95], v4, s[16:19], s40 offen sc1
  v_mul_f32 v80, v40, v5
  v_mul_f32 v81, v41, v5
  v_mul_f32 v82, v42, v5
  v_mul_f32 v83, v43, v5
  v_exp_f32 v84, v80
  v_exp_f32 v85, v81
  v_exp_f32 v86, v82
  v_exp_f32 v87, v83
  v_add_f32 v84, 1.0, v84
  v_add_f32 v85, 1.0, v85
  v_add_f32 v86, 1.0, v86
  v_add_f32 v87, 1.0, v87
  v_fma_f32 v88, v84, v84, 1.0
  v_fma_f32 v89, v85, v85, 1.0
  v_fma_f32 v90, v86, v86, 1.0
  v_fma_f32 v91, v87, v87, 1.0
  v_rcp_f32 v88, v88
  v_rcp_f32 v89, v89
  v_rcp_f32 v90, v90
  v_rcp_f32 v91, v91
  v_fmaak_f32 v88, v88, v7, 0x3f317218
  v_fmaak_f32 v89, v89, v7, 0x3f317218
  v_fmaak_f32 v90, v90, v7, 0x3f317218
  v_fmaak_f32 v91, v91, v7, 0x3f317218
  v_mul_f32 v80, v80, v88
  v_mul_f32 v81, v81, v89
  v_mul_f32 v82, v82, v90
  v_mul_f32 v83, v83, v91
  v_cvt_pk_bf16_f32 v96, v80, v81
  v_cvt_pk_bf16_f32 v97, v82, v83
  v_mul_f32 v80, v44, v5
  v_mul_f32 v81, v45, v5
  v_mul_f32 v82, v46, v5
  v_mul_f32 v83, v47, v5
  v_exp_f32 v84, v80
  v_exp_f32 v85, v81
  v_exp_f32 v86, v82
  v_exp_f32 v87, v83
  v_add_f32 v84, 1.0, v84
  v_add_f32 v85, 1.0, v85
  v_add_f32 v86, 1.0, v86
  v_add_f32 v87, 1.0, v87
  v_fma_f32 v88, v84, v84, 1.0
  v_fma_f32 v89, v85, v85, 1.0
  v_fma_f32 v90, v86, v86, 1.0
  v_fma_f32 v91, v87, v87, 1.0
  v_rcp_f32 v88, v88
  v_rcp_f32 v89, v89
  v_rcp_f32 v90, v90
  v_rcp_f32 v91, v91
  v_fmaak_f32 v88, v88, v7, 0x3f317218
  v_fmaak_f32 v89, v89, v7, 0x3f317218
  v_fmaak_f32 v90, v90, v7, 0x3f317218
  v_fmaak_f32 v91, v91, v7, 0x3f317218
  v_mul_f32 v80, v80, v88
  v_mul_f32 v81, v81, v89
  v_mul_f32 v82, v82, v90
  v_mul_f32 v83, v83, v91
  v_cvt_pk_bf16_f32 v98, v80, v81
  v_cvt_pk_bf16_f32 v99, v82, v83
  buffer_store_dwordx4 v[96:99], v4, s[16:19], s40 offen offset:1024 sc1
  s_branch lnqkv_kernel_fin
lnqkv_kernel_QK:
  v_mov_b32 v4, v1
  v_add_u32 v6, 65536, v1
  s_cmp_lt_u32 s35, 16
  s_cselect_b32 s3, 0x3eb8aa3b, 1.0
  v_mul_f32 v7, s3, v5
  s_lshl_b32 s3, s35, 17
  s_lshl_b32 s4, s37, 10
  s_add_u32 s41, s3, s4
  s_mov_b32 s46, 131072
  s_barrier
  ds_read_b64_tr_b16 v[48:49], v2 offset:0
  ds_read_b64_tr_b16 v[50:51], v2 offset:1024
  ds_read_b64_tr_b16 v[52:53], v2 offset:2048
  ds_read_b64_tr_b16 v[54:55], v2 offset:3072
  ds_read_b64_tr_b16 v[56:57], v2 offset:4096
  ds_read_b64_tr_b16 v[58:59], v2 offset:5120
  ds_read_b64_tr_b16 v[60:61], v2 offset:6144
  ds_read_b64_tr_b16 v[62:63], v2 offset:7168
lnqkv_kernel_QK_loop:
  s_waitcnt lgkmcnt(4)
  v_mfma_f32_32x32x16_bf16 v[16:31], v[48:51], v[128:131], 0
  ds_read_b64_tr_b16 v[64:65], v2 offset:8192
  ds_read_b64_tr_b16 v[66:67], v2 offset:9216
  s_add_u32 s38, s38, 1
  s_bitcmp1_b32 s39, 0
  s_cselect_b32 s3, 0x10040, 64
  s_cselect_b32 s42, 1, 0
  v_xor_b32 v3, s3, v2
  v_mfma_f32_32x32x16_bf16 v[16:31], v[52:55], v[132:135], v[16:31]
  ds_read_b64_tr_b16 v[68:69], v2 offset:10240
  ds_read_b64_tr_b16 v[70:71], v2 offset:11264
  s_cmp_lt_u32 s38, s36
  s_cselect_b32 s42, s42, 0
  s_waitcnt lgkmcnt(4)
  v_mfma_f32_32x32x16_bf16 v[16:31], v[56:59], v[136:139], v[16:31]
  ds_read_b64_tr_b16 v[72:73], v2 offset:12288
  ds_read_b64_tr_b16 v[74:75], v2 offset:13312
  v_mfma_f32_32x32x16_bf16 v[16:31], v[60:63], v[140:143], v[16:31]
  ds_read_b64_tr_b16 v[76:77], v2 offset:14336
  ds_read_b64_tr_b16 v[78:79], v2 offset:15360
  v_mul_f32 v80, v32, v7
  s_waitcnt lgkmcnt(4)
  v_mfma_f32_32x32x16_bf16 v[16:31], v[64:67], v[144:147], v[16:31]
  ds_read_b64_tr_b16 v[48:49], v2 offset:16384
  ds_read_b64_tr_b16 v[50:51], v2 offset:17408
  v_mul_f32 v81, v33, v7
  v_mfma_f32_32x32x16_bf16 v[16:31], v[68:71], v[148:151], v[16:31]
  ds_read_b64_tr_b16 v[52:53], v2 offset:18432
  ds_read_b64_tr_b16 v[54:55], v2 offset:19456
  v_mul_f32 v82, v34, v7
  s_waitcnt lgkmcnt(4)
  v_mfma_f32_32x32x16_bf16 v[16:31], v[72:75], v[152:155], v[16:31]
  ds_read_b64_tr_b16 v[56:57], v2 offset:20480
  ds_read_b64_tr_b16 v[58:59], v2 offset:21504
  v_mul_f32 v83, v35, v7
  v_mfma_f32_32x32x16_bf16 v[16:31], v[76:79], v[156:159], v[16:31]
  ds_read_b64_tr_b16 v[60:61], v2 offset:22528
  ds_read_b64_tr_b16 v[62:63], v2 offset:23552
  v_cvt_pk_bf16_f32 v92, v80, v81
  s_waitcnt lgkmcnt(4)
  v_mfma_f32_32x32x16_bf16 v[16:31], v[48:51], v[160:163], v[16:31]
  ds_read_b64_tr_b16 v[64:65], v2 offset:24576
  ds_read_b64_tr_b16 v[66:67], v2 offset:25600
  v_cvt_pk_bf16_f32 v93, v82, v83
  v_mfma_f32_32x32x16_bf16 v[16:31], v[52:55], v[164:167], v[16:31]
  ds_read_b64_tr_b16 v[68:69], v2 offset:26624
  ds_read_b64_tr_b16 v[70:71], v2 offset:27648
  v_mul_f32 v80, v36, v7
  s_waitcnt lgkmcnt(4)
  v_mfma_f32_32x32x16_bf16 v[16:31], v[56:59], v[168:171], v[16:31]
  ds_read_b64_tr_b16 v[72:73], v2 offset:28672
  ds_read_b64_tr_b16 v[74:75], v2 offset:29696
  v_mul_f32 v81, v37, v7
  v_mfma_f32_32x32x16_bf16 v[16:31], v[60:63], v[172:175], v[16:31]
  ds_read_b64_tr_b16 v[76:77], v2 offset:30720
  ds_read_b64_tr_b16 v[78:79], v2 offset:31744
  v_mul_f32 v82, v38, v7
  s_waitcnt lgkmcnt(4)
  v_mfma_f32_32x32x16_bf16 v[16:31], v[64:67], v[176:179], v[16:31]
  ds_read_b64_tr_b16 v[48:49], v2 offset:32768
  ds_read_b64_tr_b16 v[50:51], v2 offset:33792
  v_mul_f32 v83, v39, v7
  v_mfma_f32_32x32x16_bf16 v[16:31], v[68:71], v[180:183], v[16:31]
  ds_read_b64_tr_b16 v[52:53], v2 offset:34816
  ds_read_b64_tr_b16 v[54:55], v2 offset:35840
  v_cvt_pk_bf16_f32 v94, v80, v81
  s_waitcnt lgkmcnt(4)
  v_mfma_f32_32x32x16_bf16 v[16:31], v[72:75], v[184:187], v[16:31]
  ds_read_b64_tr_b16 v[56:57], v2 offset:36864
  ds_read_b64_tr_b16 v[58:59], v2 offset:37888
  v_cvt_pk_bf16_f32 v95, v82, v83
  v_mfma_f32_32x32x16_bf16 v[16:31], v[76:79], v[188:191], v[16:31]
  ds_read_b64_tr_b16 v[60:61], v2 offset:38912
  ds_read_b64_tr_b16 v[62:63], v2 offset:39936
  buffer_store_dwordx4 v[92:95], v4, s[16:19], s40 offen sc1
  s_waitcnt lgkmcnt(4)
  v_mfma_f32_32x32x16_bf16 v[16:31], v[48:51], v[192:195], v[16:31]
  ds_read_b64_tr_b16 v[64:65], v2 offset:40960
  ds_read_b64_tr_b16 v[66:67], v2 offset:41984
  v_mul_f32 v80, v40, v7
  v_mfma_f32_32x32x16_bf16 v[16:31], v[52:55], v[196:199], v[16:31]
  ds_read_b64_tr_b16 v[68:69], v2 offset:43008
  ds_read_b64_tr_b16 v[70:71], v2 offset:44032
  v_mul_f32 v81, v41, v7
  s_waitcnt lgkmcnt(4)
  v_mfma_f32_32x32x16_bf16 v[16:31], v[56:59], v[200:203], v[16:31]
  ds_read_b64_tr_b16 v[72:73], v2 offset:45056
  ds_read_b64_tr_b16 v[74:75], v2 offset:46080
  v_mul_f32 v82, v42, v7
  v_mfma_f32_32x32x16_bf16 v[16:31], v[60:63], v[204:207], v[16:31]
  ds_read_b64_tr_b16 v[76:77], v2 offset:47104
  ds_read_b64_tr_b16 v[78:79], v2 offset:48128
  v_mul_f32 v83, v43, v7
  s_waitcnt lgkmcnt(4)
  v_mfma_f32_32x32x16_bf16 v[16:31], v[64:67], v[208:211], v[16:31]
  ds_read_b64_tr_b16 v[48:49], v2 offset:49152
  ds_read_b64_tr_b16 v[50:51], v2 offset:50176
  v_cvt_pk_bf16_f32 v96, v80, v81
  v_mfma_f32_32x32x16_bf16 v[16:31], v[68:71], v[212:215], v[16:31]
  ds_read_b64_tr_b16 v[52:53], v2 offset:51200
  ds_read_b64_tr_b16 v[54:55], v2 offset:52224
  v_cvt_pk_bf16_f32 v97, v82, v83
  s_waitcnt lgkmcnt(4)
  v_mfma_f32_32x32x16_bf16 v[16:31], v[72:75], v[216:219], v[16:31]
  ds_read_b64_tr_b16 v[56:57], v2 offset:53248
  ds_read_b64_tr_b16 v[58:59], v2 offset:54272
  v_mul_f32 v80, v44, v7
  v_mfma_f32_32x32x16_bf16 v[16:31], v[76:79], v[220:223], v[16:31]
  ds_read_b64_tr_b16 v[60:61], v2 offset:55296
  ds_read_b64_tr_b16 v[62:63], v2 offset:56320
  v_mul_f32 v81, v45, v7
  s_waitcnt lgkmcnt(4)
  v_mfma_f32_32x32x16_bf16 v[16:31], v[48:51], v[224:227], v[16:31]
  ds_read_b64_tr_b16 v[64:65], v2 offset:57344
  ds_read_b64_tr_b16 v[66:67], v2 offset:58368
  v_mul_f32 v82, v46, v7
  v_mfma_f32_32x32x16_bf16 v[16:31], v[52:55], v[228:231], v[16:31]
  ds_read_b64_tr_b16 v[68:69], v2 offset:59392
  ds_read_b64_tr_b16 v[70:71], v2 offset:60416
  v_mul_f32 v83, v47, v7
  s_waitcnt lgkmcnt(4)
  v_mfma_f32_32x32x16_bf16 v[16:31], v[56:59], v[232:235], v[16:31]
  ds_read_b64_tr_b16 v[72:73], v2 offset:61440
  ds_read_b64_tr_b16 v[74:75], v2 offset:62464
  v_cvt_pk_bf16_f32 v98, v80, v81
  v_mfma_f32_32x32x16_bf16 v[16:31], v[60:63], v[236:239], v[16:31]
  ds_read_b64_tr_b16 v[76:77], v2 offset:63488
  ds_read_b64_tr_b16 v[78:79], v2 offset:64512
  v_cvt_pk_bf16_f32 v99, v82, v83
  s_waitcnt lgkmcnt(4)
  v_mfma_f32_32x32x16_bf16 v[16:31], v[64:67], v[240:243], v[16:31]
  buffer_store_dwordx4 v[96:99], v6, s[16:19], s40 offen sc1
  v_mfma_f32_32x32x16_bf16 v[16:31], v[68:71], v[244:247], v[16:31]
  s_mov_b32 s40, s41
  s_add_u32 s41, s41, s46
  s_add_u32 s39, s39, 1
  s_waitcnt lgkmcnt(0)
  s_cmp_eq_u32 s42, 0
  v_mfma_f32_32x32x16_bf16 v[16:31], v[72:75], v[248:251], v[16:31]
  s_cbranch_scc1 lnqkv_kernel_QK_nb
  s_barrier
lnqkv_kernel_QK_nb:
  ds_read_b64_tr_b16 v[48:49], v3 offset:0
  ds_read_b64_tr_b16 v[50:51], v3 offset:1024
  ds_read_b64_tr_b16 v[52:53], v3 offset:2048
  ds_read_b64_tr_b16 v[54:55], v3 offset:3072
  v_mfma_f32_32x32x16_bf16 v[32:47], v[76:79], v[252:255], v[16:31]
  ds_read_b64_tr_b16 v[56:57], v3 offset:4096
  ds_read_b64_tr_b16 v[58:59], v3 offset:5120
  ds_read_b64_tr_b16 v[60:61], v3 offset:6144
  ds_read_b64_tr_b16 v[62:63], v3 offset:7168
  v_mov_b32 v2, v3
  s_cmp_lt_u32 s38, s36
  s_cbranch_scc1 lnqkv_kernel_QK_loop
  s_nop 9
  v_mul_f32 v80, v32, v7
  v_mul_f32 v81, v33, v7
  v_mul_f32 v82, v34, v7
  v_mul_f32 v83, v35, v7
  v_cvt_pk_bf16_f32 v92, v80, v81
  v_cvt_pk_bf16_f32 v93, v82, v83
  v_mul_f32 v80, v36, v7
  v_mul_f32 v81, v37, v7
  v_mul_f32 v82, v38, v7
  v_mul_f32 v83, v39, v7
  v_cvt_pk_bf16_f32 v94, v80, v81
  v_cvt_pk_bf16_f32 v95, v82, v83
  buffer_store_dwordx4 v[92:95], v4, s[16:19], s40 offen sc1
  v_mul_f32 v80, v40, v7
  v_mul_f32 v81, v41, v7
  v_mul_f32 v82, v42, v7
  v_mul_f32 v83, v43, v7
  v_cvt_pk_bf16_f32 v96, v80, v81
  v_cvt_pk_bf16_f32 v97, v82, v83
  v_mul_f32 v80, v44, v7
  v_mul_f32 v81, v45, v7
  v_mul_f32 v82, v46, v7
  v_mul_f32 v83, v47, v7
  v_cvt_pk_bf16_f32 v98, v80, v81
  v_cvt_pk_bf16_f32 v99, v82, v83
  buffer_store_dwordx4 v[96:99], v6, s[16:19], s40 offen sc1
  s_branch lnqkv_kernel_fin
lnqkv_kernel_V:
  s_lshl_b32 s3, s32, 7
  s_add_u32 s3, s3, 153600
  v_and_b32 v8, 31, v0
  v_lshlrev_b32 v8, 2, v8
  v_add_u32 v8, s3, v8
  ds_write_b32 v8, v5
  v_bfe_u32 v9, v0, 5, 1
  v_lshlrev_b32 v9, 4, v9
  v_add_u32 v9, s3, v9
  s_waitcnt lgkmcnt(0)
  ds_read_b128 v[108:111], v9 offset:0
  ds_read_b128 v[112:115], v9 offset:32
  ds_read_b128 v[116:119], v9 offset:64
  ds_read_b128 v[120:123], v9 offset:96
  v_bfe_u32 v8, v0, 4, 1
  v_lshlrev_b32 v8, 16, v8
  v_bfe_u32 v9, v0, 5, 1
  v_lshlrev_b32 v9, 8, v9
  v_add_u32 v8, v8, v9
  v_and_b32 v9, 15, v0
  v_lshlrev_b32 v9, 4, v9
  v_add_u32 v4, v8, v9
  s_lshl_b32 s3, s35, 17
  s_lshl_b32 s4, s37, 10
  s_add_u32 s41, s3, s4
  s_mov_b32 s46, 131072
  s_waitcnt lgkmcnt(0)
  s_barrier
  ds_read_b64_tr_b16 v[48:49], v2 offset:0
  ds_read_b64_tr_b16 v[50:51], v2 offset:1024
  ds_read_b64_tr_b16 v[52:53], v2 offset:2048
  ds_read_b64_tr_b16 v[54:55], v2 offset:3072
  ds_read_b64_tr_b16 v[56:57], v2 offset:4096
  ds_read_b64_tr_b16 v[58:59], v2 offset:5120
  ds_read_b64_tr_b16 v[60:61], v2 offset:6144
  ds_read_b64_tr_b16 v[62:63], v2 offset:7168
lnqkv_kernel_V_loop:
  s_waitcnt lgkmcnt(4)
  v_mfma_f32_32x32x16_bf16 v[16:31], v[128:131], v[48:51], 0
  ds_read_b64_tr_b16 v[64:65], v2 offset:8192
  ds_read_b64_tr_b16 v[66:67], v2 offset:9216
  s_add_u32 s38, s38, 1
  s_bitcmp1_b32 s39, 0
  s_cselect_b32 s3, 0x10040, 64
  s_cselect_b32 s42, 1, 0
  v_xor_b32 v3, s3, v2
  v_mfma_f32_32x32x16_bf16 v[16:31], v[132:135], v[52:55], v[16:31]
  ds_read_b64_tr_b16 v[68:69], v2 offset:10240
  ds_read_b64_tr_b16 v[70:71], v2 offset:11264
  s_cmp_lt_u32 s38, s36
  s_cselect_b32 s42, s42, 0
  s_waitcnt lgkmcnt(4)
  v_mfma_f32_32x32x16_bf16 v[16:31], v[136:139], v[56:59], v[16:31]
  ds_read_b64_tr_b16 v[72:73], v2 offset:12288
  ds_read_b64_tr_b16 v[74:75], v2 offset:13312
  v_mfma_f32_32x32x16_bf16 v[16:31], v[140:143], v[60:63], v[16:31]
  ds_read_b64_tr_b16 v[76:77], v2 offset:14336
  ds_read_b64_tr_b16 v[78:79], v2 offset:15360
  v_mul_f32 v80, v32, v108
  s_waitcnt lgkmcnt(4)
  v_mfma_f32_32x32x16_bf16 v[16:31], v[144:147], v[64:67], v[16:31]
  ds_read_b64_tr_b16 v[48:49], v2 offset:16384
  ds_read_b64_tr_b16 v[50:51], v2 offset:17408
  v_mul_f32 v81, v33, v109
  v_mfma_f32_32x32x16_bf16 v[16:31], v[148:151], v[68:71], v[16:31]
  ds_read_b64_tr_b16 v[52:53], v2 offset:18432
  ds_read_b64_tr_b16 v[54:55], v2 offset:19456
  v_mul_f32 v82, v34, v110
  s_waitcnt lgkmcnt(4)
  v_mfma_f32_32x32x16_bf16 v[16:31], v[152:155], v[72:75], v[16:31]
  ds_read_b64_tr_b16 v[56:57], v2 offset:20480
  ds_read_b64_tr_b16 v[58:59], v2 offset:21504
  v_mul_f32 v83, v35, v111
  v_mfma_f32_32x32x16_bf16 v[16:31], v[156:159], v[76:79], v[16:31]
  ds_read_b64_tr_b16 v[60:61], v2 offset:22528
  ds_read_b64_tr_b16 v[62:63], v2 offset:23552
  v_cvt_pk_bf16_f32 v92, v80, v81
  s_waitcnt lgkmcnt(4)
  v_mfma_f32_32x32x16_bf16 v[16:31], v[160:163], v[48:51], v[16:31]
  ds_read_b64_tr_b16 v[64:65], v2 offset:24576
  ds_read_b64_tr_b16 v[66:67], v2 offset:25600
  v_cvt_pk_bf16_f32 v93, v82, v83
  v_mfma_f32_32x32x16_bf16 v[16:31], v[164:167], v[52:55], v[16:31]
  ds_read_b64_tr_b16 v[68:69], v2 offset:26624
  ds_read_b64_tr_b16 v[70:71], v2 offset:27648
  v_mul_f32 v80, v36, v112
  s_waitcnt lgkmcnt(4)
  v_mfma_f32_32x32x16_bf16 v[16:31], v[168:171], v[56:59], v[16:31]
  ds_read_b64_tr_b16 v[72:73], v2 offset:28672
  ds_read_b64_tr_b16 v[74:75], v2 offset:29696
  v_mul_f32 v81, v37, v113
  v_mfma_f32_32x32x16_bf16 v[16:31], v[172:175], v[60:63], v[16:31]
  ds_read_b64_tr_b16 v[76:77], v2 offset:30720
  ds_read_b64_tr_b16 v[78:79], v2 offset:31744
  v_mul_f32 v82, v38, v114
  s_waitcnt lgkmcnt(4)
  v_mfma_f32_32x32x16_bf16 v[16:31], v[176:179], v[64:67], v[16:31]
  ds_read_b64_tr_b16 v[48:49], v2 offset:32768
  ds_read_b64_tr_b16 v[50:51], v2 offset:33792
  v_mul_f32 v83, v39, v115
  v_mfma_f32_32x32x16_bf16 v[16:31], v[180:183], v[68:71], v[16:31]
  ds_read_b64_tr_b16 v[52:53], v2 offset:34816
  ds_read_b64_tr_b16 v[54:55], v2 offset:35840
  v_cvt_pk_bf16_f32 v94, v80, v81
  s_waitcnt lgkmcnt(4)
  v_mfma_f32_32x32x16_bf16 v[16:31], v[184:187], v[72:75], v[16:31]
  ds_read_b64_tr_b16 v[56:57], v2 offset:36864
  ds_read_b64_tr_b16 v[58:59], v2 offset:37888
  v_cvt_pk_bf16_f32 v95, v82, v83
  v_mfma_f32_32x32x16_bf16 v[16:31], v[188:191], v[76:79], v[16:31]
  ds_read_b64_tr_b16 v[60:61], v2 offset:38912
  ds_read_b64_tr_b16 v[62:63], v2 offset:39936
  buffer_store_dwordx4 v[92:95], v4, s[16:19], s40 offen sc1
  s_waitcnt lgkmcnt(4)
  v_mfma_f32_32x32x16_bf16 v[16:31], v[192:195], v[48:51], v[16:31]
  ds_read_b64_tr_b16 v[64:65], v2 offset:40960
  ds_read_b64_tr_b16 v[66:67], v2 offset:41984
  v_mul_f32 v80, v40, v116
  v_mfma_f32_32x32x16_bf16 v[16:31], v[196:199], v[52:55], v[16:31]
  ds_read_b64_tr_b16 v[68:69], v2 offset:43008
  ds_read_b64_tr_b16 v[70:71], v2 offset:44032
  v_mul_f32 v81, v41, v117
  s_waitcnt lgkmcnt(4)
  v_mfma_f32_32x32x16_bf16 v[16:31], v[200:203], v[56:59], v[16:31]
  ds_read_b64_tr_b16 v[72:73], v2 offset:45056
  ds_read_b64_tr_b16 v[74:75], v2 offset:46080
  v_mul_f32 v82, v42, v118
  v_mfma_f32_32x32x16_bf16 v[16:31], v[204:207], v[60:63], v[16:31]
  ds_read_b64_tr_b16 v[76:77], v2 offset:47104
  ds_read_b64_tr_b16 v[78:79], v2 offset:48128
  v_mul_f32 v83, v43, v119
  s_waitcnt lgkmcnt(4)
  v_mfma_f32_32x32x16_bf16 v[16:31], v[208:211], v[64:67], v[16:31]
  ds_read_b64_tr_b16 v[48:49], v2 offset:49152
  ds_read_b64_tr_b16 v[50:51], v2 offset:50176
  v_cvt_pk_bf16_f32 v96, v80, v81
  v_mfma_f32_32x32x16_bf16 v[16:31], v[212:215], v[68:71], v[16:31]
  ds_read_b64_tr_b16 v[52:53], v2 offset:51200
  ds_read_b64_tr_b16 v[54:55], v2 offset:52224
  v_cvt_pk_bf16_f32 v97, v82, v83
  s_waitcnt lgkmcnt(4)
  v_mfma_f32_32x32x16_bf16 v[16:31], v[216:219], v[72:75], v[16:31]
  ds_read_b64_tr_b16 v[56:57], v2 offset:53248
  ds_read_b64_tr_b16 v[58:59], v2 offset:54272
  v_mul_f32 v80, v44, v120
  v_mfma_f32_32x32x16_bf16 v[16:31], v[220:223], v[76:79], v[16:31]
  ds_read_b64_tr_b16 v[60:61], v2 offset:55296
  ds_read_b64_tr_b16 v[62:63], v2 offset:56320
  v_mul_f32 v81, v45, v121
  s_waitcnt lgkmcnt(4)
  v_mfma_f32_32x32x16_bf16 v[16:31], v[224:227], v[48:51], v[16:31]
  ds_read_b64_tr_b16 v[64:65], v2 offset:57344
  ds_read_b64_tr_b16 v[66:67], v2 offset:58368
  v_mul_f32 v82, v46, v122
  v_mfma_f32_32x32x16_bf16 v[16:31], v[228:231], v[52:55], v[16:31]
  ds_read_b64_tr_b16 v[68:69], v2 offset:59392
  ds_read_b64_tr_b16 v[70:71], v2 offset:60416
  v_mul_f32 v83, v47, v123
  s_waitcnt lgkmcnt(4)
  v_mfma_f32_32x32x16_bf16 v[16:31], v[232:235], v[56:59], v[16:31]
  ds_read_b64_tr_b16 v[72:73], v2 offset:61440
  ds_read_b64_tr_b16 v[74:75], v2 offset:62464
  v_cvt_pk_bf16_f32 v98, v80, v81
  v_mfma_f32_32x32x16_bf16 v[16:31], v[236:239], v[60:63], v[16:31]
  ds_read_b64_tr_b16 v[76:77], v2 offset:63488
  ds_read_b64_tr_b16 v[78:79], v2 offset:64512
  v_cvt_pk_bf16_f32 v99, v82, v83
  s_waitcnt lgkmcnt(4)
  v_mfma_f32_32x32x16_bf16 v[16:31], v[240:243], v[64:67], v[16:31]
  buffer_store_dwordx4 v[96:99], v4, s[16:19], s40 offen offset:512 sc1
  v_mfma_f32_32x32x16_bf16 v[16:31], v[244:247], v[68:71], v[16:31]
  s_mov_b32 s40, s41
  s_add_u32 s41, s41, s46
  s_add_u32 s39, s39, 1
  s_waitcnt lgkmcnt(0)
  s_cmp_eq_u32 s42, 0
  v_mfma_f32_32x32x16_bf16 v[16:31], v[248:251], v[72:75], v[16:31]
  s_cbranch_scc1 lnqkv_kernel_V_nb
  s_barrier
lnqkv_kernel_V_nb:
  ds_read_b64_tr_b16 v[48:49], v3 offset:0
  ds_read_b64_tr_b16 v[50:51], v3 offset:1024
  ds_read_b64_tr_b16 v[52:53], v3 offset:2048
  ds_read_b64_tr_b16 v[54:55], v3 offset:3072
  v_mfma_f32_32x32x16_bf16 v[32:47], v[252:255], v[76:79], v[16:31]
  ds_read_b64_tr_b16 v[56:57], v3 offset:4096
  ds_read_b64_tr_b16 v[58:59], v3 offset:5120
  ds_read_b64_tr_b16 v[60:61], v3 offset:6144
  ds_read_b64_tr_b16 v[62:63], v3 offset:7168
  v_mov_b32 v2, v3
  s_cmp_lt_u32 s38, s36
  s_cbranch_scc1 lnqkv_kernel_V_loop
  s_nop 9
  v_mul_f32 v80, v32, v108
  v_mul_f32 v81, v33, v109
  v_mul_f32 v82, v34, v110
  v_mul_f32 v83, v35, v111
  v_cvt_pk_bf16_f32 v92, v80, v81
  v_cvt_pk_bf16_f32 v93, v82, v83
  v_mul_f32 v80, v36, v112
  v_mul_f32 v81, v37, v113
  v_mul_f32 v82, v38, v114
  v_mul_f32 v83, v39, v115
  v_cvt_pk_bf16_f32 v94, v80, v81
  v_cvt_pk_bf16_f32 v95, v82, v83
  buffer_store_dwordx4 v[92:95], v4, s[16:19], s40 offen sc1
  v_mul_f32 v80, v40, v116
  v_mul_f32 v81, v41, v117
  v_mul_f32 v82, v42, v118
  v_mul_f32 v83, v43, v119
  v_cvt_pk_bf16_f32 v96, v80, v81
  v_cvt_pk_bf16_f32 v97, v82, v83
  v_mul_f32 v80, v44, v120
  v_mul_f32 v81, v45, v121
  v_mul_f32 v82, v46, v122
  v_mul_f32 v83, v47, v123
  v_cvt_pk_bf16_f32 v98, v80, v81
  v_cvt_pk_bf16_f32 v99, v82, v83
  buffer_store_dwordx4 v[96:99], v4, s[16:19], s40 offen offset:512 sc1
  s_branch lnqkv_kernel_fin
lnqkv_kernel_loader:
  s_cmp_lt_u32 s34, 10
  s_cselect_b32 s4, s56, s50
  s_cselect_b32 s5, s57, s51
  s_mov_b32 s12, s4
  s_and_b32 s13, s5, 0xffff
  s_lshl_b32 s14, s44, 9
  s_mov_b32 s15, 0x00020000
  s_sub_u32 s47, s32, 4
  v_bfe_u32 v3, v0, 3, 3
  v_mul_lo_u32 v2, s44, v3
  v_and_b32 v3, 7, v0
  v_bfe_u32 v4, v0, 4, 1
  v_lshlrev_b32 v4, 2, v4
  v_xor_b32 v3, v3, v4
  v_lshlrev_b32 v3, 4, v3
  v_add_u32 v2, v2, v3
  s_lshr_b32 s43, s35, 1
  s_lshl_b32 s43, s43, 7
  s_lshl_b32 s66, s44, 4
  s_lshl_b32 s67, s44, 3
  s_mul_i32 s67, s67, s47
  s_lshr_b32 s68, s2, 3
  s_and_b32 s68, s68, 3
  s_mov_b32 s8, s48
  s_and_b32 s9, s49, 0xffff
  s_mov_b32 s10, 0x200000
  s_mov_b32 s11, 0x00020000
  v_and_b32 v8, 63, v0
  s_lshl_b32 s3, s47, 6
  v_add_u32 v9, s3, v8
  v_lshlrev_b32 v9, 10, v9
  s_lshl_b32 s3, s33, 17
  s_lshr_b32 s4, s2, 5
  s_lshl_b32 s4, s4, 7
  s_add_u32 s3, s3, s4
  buffer_load_dword v20, v9, s[8:11], s3 offen
  s_waitcnt vmcnt(0)
  s_cmp_eq_u32 s47, 0
  s_cselect_b32 s72, s50, s56
  s_cselect_b32 s73, s51, s57
  s_cselect_b32 s3, 48, 56
  s_and_b32 s73, s73, 0xffff
  s_mul_i32 s74, s3, 32768
  s_mov_b32 s75, 0x00020000
  s_mul_i32 s4, s3, s2
  s_lshl_b32 s4, s4, 7
  s_sub_u32 s3, s3, 1
  v_and_b32 v9, 63, v0
  v_min_u32 v9, s3, v9
  v_lshlrev_b32 v9, 7, v9
  buffer_load_dword v24, v9, s[72:75], s4 offen
  s_cmp_lg_u32 s2, 0
  s_cbranch_scc1 lnqkv_kernel_nz
  s_mov_b32 s16, s62
  s_and_b32 s17, s63, 0xffff
  s_mov_b32 s18, 0x10000000
  s_mov_b32 s19, 0x00020000
  v_and_b32 v9, 63, v0
  v_lshlrev_b32 v9, 7, v9
  v_mov_b32 v10, 0
  s_mov_b32 s3, 27262976
  buffer_store_dword v10, v9, s[16:19], s3 offen sc1
lnqkv_kernel_nz:
  s_barrier
  s_lshl_b32 s7, s47, 10
  s_add_u32 s7, s7, 0
  s_add_u32 m0, s7, 0
  s_mul_i32 s42, s66, 0
  s_add_u32 s42, s42, s67
  s_add_u32 s42, s42, s43
  buffer_load_dwordx4 v2, s[12:15], s42 offen lds
  s_add_u32 m0, m0, 2048
  s_add_u32 s42, s42, s66
  buffer_load_dwordx4 v2, s[12:15], s42 offen lds
  s_add_u32 m0, m0, 2048
  s_add_u32 s42, s42, s66
  buffer_load_dwordx4 v2, s[12:15], s42 offen lds
  s_add_u32 m0, m0, 2048
  s_add_u32 s42, s42, s66
  buffer_load_dwordx4 v2, s[12:15], s42 offen lds
  s_add_u32 m0, m0, 2048
  s_add_u32 s42, s42, s66
  buffer_load_dwordx4 v2, s[12:15], s42 offen lds
  s_add_u32 m0, m0, 2048
  s_add_u32 s42, s42, s66
  buffer_load_dwordx4 v2, s[12:15], s42 offen lds
  s_add_u32 m0, m0, 2048
  s_add_u32 s42, s42, s66
  buffer_load_dwordx4 v2, s[12:15], s42 offen lds
  s_add_u32 m0, m0, 2048
  s_add_u32 s42, s42, s66
  buffer_load_dwordx4 v2, s[12:15], s42 offen lds
  s_add_u32 m0, m0, 2048
  s_add_u32 s42, s42, s66
  buffer_load_dwordx4 v2, s[12:15], s42 offen lds
  s_add_u32 m0, m0, 2048
  s_add_u32 s42, s42, s66
  buffer_load_dwordx4 v2, s[12:15], s42 offen lds
  s_add_u32 m0, m0, 2048
  s_add_u32 s42, s42, s66
  buffer_load_dwordx4 v2, s[12:15], s42 offen lds
  s_add_u32 m0, m0, 2048
  s_add_u32 s42, s42, s66
  buffer_load_dwordx4 v2, s[12:15], s42 offen lds
  s_add_u32 m0, m0, 2048
  s_add_u32 s42, s42, s66
  buffer_load_dwordx4 v2, s[12:15], s42 offen lds
  s_add_u32 m0, m0, 2048
  s_add_u32 s42, s42, s66
  buffer_load_dwordx4 v2, s[12:15], s42 offen lds
  s_add_u32 m0, m0, 2048
  s_add_u32 s42, s42, s66
  buffer_load_dwordx4 v2, s[12:15], s42 offen lds
  s_add_u32 m0, m0, 2048
  s_add_u32 s42, s42, s66
  buffer_load_dwordx4 v2, s[12:15], s42 offen lds
  s_mov_b32 s24, s52
  s_and_b32 s25, s53, 0xffff
  s_mov_b32 s26, 0x80000
  s_mov_b32 s27, 0x00020000
  s_mov_b32 s28, s60
  s_and_b32 s29, s61, 0xffff
  s_mov_b32 s30, 0x1c0000
  s_mov_b32 s31, 0x00020000
  s_mov_b32 s16, s62
  s_and_b32 s17, s63, 0xffff
  s_mov_b32 s18, 0x10000000
  s_mov_b32 s19, 0x00020000
  s_barrier
  s_lshl_b32 s7, s47, 10
  s_add_u32 s7, s7, 0
  s_add_u32 m0, s7, 32768
  s_mul_i32 s42, s66, 16
  s_add_u32 s42, s42, s67
  s_add_u32 s42, s42, s43
  buffer_load_dwordx4 v2, s[12:15], s42 offen lds
  s_add_u32 m0, m0, 2048
  s_add_u32 s42, s42, s66
  buffer_load_dwordx4 v2, s[12:15], s42 offen lds
  s_add_u32 m0, m0, 2048
  s_add_u32 s42, s42, s66
  buffer_load_dwordx4 v2, s[12:15], s42 offen lds
  s_add_u32 m0, m0, 2048
  s_add_u32 s42, s42, s66
  buffer_load_dwordx4 v2, s[12:15], s42 offen lds
  s_add_u32 m0, m0, 2048
  s_add_u32 s42, s42, s66
  buffer_load_dwordx4 v2, s[12:15], s42 offen lds
  s_add_u32 m0, m0, 2048
  s_add_u32 s42, s42, s66
  buffer_load_dwordx4 v2, s[12:15], s42 offen lds
  s_add_u32 m0, m0, 2048
  s_add_u32 s42, s42, s66
  buffer_load_dwordx4 v2, s[12:15], s42 offen lds
  s_add_u32 m0, m0, 2048
  s_add_u32 s42, s42, s66
  buffer_load_dwordx4 v2, s[12:15], s42 offen lds
  s_add_u32 m0, m0, 2048
  s_add_u32 s42, s42, s66
  buffer_load_dwordx4 v2, s[12:15], s42 offen lds
  s_add_u32 m0, m0, 2048
  s_add_u32 s42, s42, s66
  buffer_load_dwordx4 v2, s[12:15], s42 offen lds
  s_add_u32 m0, m0, 2048
  s_add_u32 s42, s42, s66
  buffer_load_dwordx4 v2, s[12:15], s42 offen lds
  s_add_u32 m0, m0, 2048
  s_add_u32 s42, s42, s66
  buffer_load_dwordx4 v2, s[12:15], s42 offen lds
  s_add_u32 m0, m0, 2048
  s_add_u32 s42, s42, s66
  buffer_load_dwordx4 v2, s[12:15], s42 offen lds
  s_add_u32 m0, m0, 2048
  s_add_u32 s42, s42, s66
  buffer_load_dwordx4 v2, s[12:15], s42 offen lds
  s_add_u32 m0, m0, 2048
  s_add_u32 s42, s42, s66
  buffer_load_dwordx4 v2, s[12:15], s42 offen lds
  s_add_u32 m0, m0, 2048
  s_add_u32 s42, s42, s66
  buffer_load_dwordx4 v2, s[12:15], s42 offen lds
  s_add_u32 s43, s43, 128
  s_lshl_b32 s7, s47, 10
  s_add_u32 s7, s7, 65536
  s_add_u32 m0, s7, 0
  s_mul_i32 s42, s66, 0
  s_add_u32 s42, s42, s67
  s_add_u32 s42, s42, s43
  buffer_load_dwordx4 v2, s[12:15], s42 offen lds
  s_add_u32 m0, m0, 2048
  s_add_u32 s42, s42, s66
  buffer_load_dwordx4 v2, s[12:15], s42 offen lds
  s_add_u32 m0, m0, 2048
  s_add_u32 s42, s42, s66
  buffer_load_dwordx4 v2, s[12:15], s42 offen lds
  s_add_u32 m0, m0, 2048
  s_add_u32 s42, s42, s66
  buffer_load_dwordx4 v2, s[12:15], s42 offen lds
  s_add_u32 m0, m0, 2048
  s_add_u32 s42, s42, s66
  buffer_load_dwordx4 v2, s[12:15], s42 offen lds
  s_add_u32 m0, m0, 2048
  s_add_u32 s42, s42, s66
  buffer_load_dwordx4 v2, s[12:15], s42 offen lds
  s_add_u32 m0, m0, 2048
  s_add_u32 s42, s42, s66
  buffer_load_dwordx4 v2, s[12:15], s42 offen lds
  s_add_u32 m0, m0, 2048
  s_add_u32 s42, s42, s66
  buffer_load_dwordx4 v2, s[12:15], s42 offen lds
  s_add_u32 m0, m0, 2048
  s_add_u32 s42, s42, s66
  buffer_load_dwordx4 v2, s[12:15], s42 offen lds
  s_add_u32 m0, m0, 2048
  s_add_u32 s42, s42, s66
  buffer_load_dwordx4 v2, s[12:15], s42 offen lds
  s_add_u32 m0, m0, 2048
  s_add_u32 s42, s42, s66
  buffer_load_dwordx4 v2, s[12:15], s42 offen lds
  s_add_u32 m0, m0, 2048
  s_add_u32 s42, s42, s66
  buffer_load_dwordx4 v2, s[12:15], s42 offen lds
  s_add_u32 m0, m0, 2048
  s_add_u32 s42, s42, s66
  buffer_load_dwordx4 v2, s[12:15], s42 offen lds
  s_add_u32 m0, m0, 2048
  s_add_u32 s42, s42, s66
  buffer_load_dwordx4 v2, s[12:15], s42 offen lds
  s_add_u32 m0, m0, 2048
  s_add_u32 s42, s42, s66
  buffer_load_dwordx4 v2, s[12:15], s42 offen lds
  s_add_u32 m0, m0, 2048
  s_add_u32 s42, s42, s66
  buffer_load_dwordx4 v2, s[12:15], s42 offen lds
  s_waitcnt vmcnt(16)
  s_barrier
  s_lshl_b32 s7, s47, 10
  s_add_u32 s7, s7, 65536
  s_add_u32 m0, s7, 32768
  s_mul_i32 s42, s66, 16
  s_add_u32 s42, s42, s67
  s_add_u32 s42, s42, s43
  buffer_load_dwordx4 v2, s[12:15], s42 offen lds
  s_add_u32 m0, m0, 2048
  s_add_u32 s42, s42, s66
  buffer_load_dwordx4 v2, s[12:15], s42 offen lds
  s_add_u32 m0, m0, 2048
  s_add_u32 s42, s42, s66
  buffer_load_dwordx4 v2, s[12:15], s42 offen lds
  s_add_u32 m0, m0, 2048
  s_add_u32 s42, s42, s66
  buffer_load_dwordx4 v2, s[12:15], s42 offen lds
  s_add_u32 m0, m0, 2048
  s_add_u32 s42, s42, s66
  buffer_load_dwordx4 v2, s[12:15], s42 offen lds
  s_add_u32 m0, m0, 2048
  s_add_u32 s42, s42, s66
  buffer_load_dwordx4 v2, s[12:15], s42 offen lds
  s_add_u32 m0, m0, 2048
  s_add_u32 s42, s42, s66
  buffer_load_dwordx4 v2, s[12:15], s42 offen lds
  s_add_u32 m0, m0, 2048
  s_add_u32 s42, s42, s66
  buffer_load_dwordx4 v2, s[12:15], s42 offen lds
  s_add_u32 m0, m0, 2048
  s_add_u32 s42, s42, s66
  buffer_load_dwordx4 v2, s[12:15], s42 offen lds
  s_add_u32 m0, m0, 2048
  s_add_u32 s42, s42, s66
  buffer_load_dwordx4 v2, s[12:15], s42 offen lds
  s_add_u32 m0, m0, 2048
  s_add_u32 s42, s42, s66
  buffer_load_dwordx4 v2, s[12:15], s42 offen lds
  s_add_u32 m0, m0, 2048
  s_add_u32 s42, s42, s66
  buffer_load_dwordx4 v2, s[12:15], s42 offen lds
  s_add_u32 m0, m0, 2048
  s_add_u32 s42, s42, s66
  buffer_load_dwordx4 v2, s[12:15], s42 offen lds
  s_add_u32 m0, m0, 2048
  s_add_u32 s42, s42, s66
  buffer_load_dwordx4 v2, s[12:15], s42 offen lds
  s_add_u32 m0, m0, 2048
  s_add_u32 s42, s42, s66
  buffer_load_dwordx4 v2, s[12:15], s42 offen lds
  s_add_u32 m0, m0, 2048
  s_add_u32 s42, s42, s66
  buffer_load_dwordx4 v2, s[12:15], s42 offen lds
  s_lshr_b32 s70, s2, 4
  s_and_b32 s69, s2, 15
  s_mul_i32 s69, s69, 9
  s_add_u32 s69, s69, s47
  s_sub_u32 s74, 5, s47
  v_bfe_u32 v3, v0, 2, 4
  v_lshlrev_b32 v3, 10, v3
  v_and_b32 v4, 3, v0
  v_lshlrev_b32 v4, 4, v4
  v_add_u32 v5, v3, v4
  v_bfe_u32 v3, v0, 5, 1
  v_lshlrev_b32 v3, 2, v3
  v_bfe_u32 v4, v0, 2, 2
  v_add_u32 v3, v3, v4
  v_lshlrev_b32 v3, 6, v3
  v_bfe_u32 v4, v0, 4, 1
  v_lshlrev_b32 v4, 5, v4
  v_add_u32 v3, v3, v4
  v_and_b32 v4, 3, v0
  v_lshlrev_b32 v4, 3, v4
  v_add_u32 v3, v3, v4
  s_lshl_b32 s3, s47, 13
  s_add_u32 s75, s3, 131072
  v_add_u32 v6, s75, v3
  v_and_b32 v7, 63, v0
  v_lshlrev_b32 v7, 4, v7
  s_mov_b32 s80, s69
  s_mov_b32 s81, s74
  s_mov_b32 s82, s75
lnqkv_kernel_sj:
  s_mov_b32 m0, s82
  s_lshl_b32 s4, s70, 6
  s_cmp_lt_u32 s80, 32
  s_cbranch_scc0 lnqkv_kernel_sj2
  s_lshl_b32 s3, s80, 14
  s_add_u32 s3, s3, s4
  buffer_load_dwordx4 v5, s[24:27], s3 offen lds
  s_branch lnqkv_kernel_sj3
lnqkv_kernel_sj2:
  s_sub_u32 s3, s80, 32
  s_lshl_b32 s3, s3, 14
  s_add_u32 s3, s3, s4
  buffer_load_dwordx4 v5, s[28:31], s3 offen lds
lnqkv_kernel_sj3:
  s_add_u32 s80, s80, 2
  s_add_u32 s82, s82, 1024
  s_sub_u32 s81, s81, 1
  s_cmp_lg_u32 s81, 0
  s_cbranch_scc1 lnqkv_kernel_sj
  s_mov_b32 s64, 1
  s_waitcnt vmcnt(4)
  s_branch lnqkv_kernel_lp1
lnqkv_kernel_lp:
  s_waitcnt vmcnt(0)
lnqkv_kernel_lp1:
  s_barrier
  s_add_u32 s64, s64, 1
  s_cmp_ge_u32 s64, s45
  s_cbranch_scc1 lnqkv_kernel_sjfin
  s_add_u32 s43, s43, 128
  s_and_b32 s65, s64, 1
  s_lshl_b32 s65, s65, 16
  s_lshl_b32 s7, s47, 10
  s_add_u32 s7, s7, s65
  s_add_u32 m0, s7, 0
  s_mul_i32 s42, s66, 0
  s_add_u32 s42, s42, s67
  s_add_u32 s42, s42, s43
  buffer_load_dwordx4 v2, s[12:15], s42 offen lds
  s_add_u32 m0, m0, 2048
  s_add_u32 s42, s42, s66
  buffer_load_dwordx4 v2, s[12:15], s42 offen lds
  s_add_u32 m0, m0, 2048
  s_add_u32 s42, s42, s66
  buffer_load_dwordx4 v2, s[12:15], s42 offen lds
  s_add_u32 m0, m0, 2048
  s_add_u32 s42, s42, s66
  buffer_load_dwordx4 v2, s[12:15], s42 offen lds
  s_add_u32 m0, m0, 2048
  s_add_u32 s42, s42, s66
  buffer_load_dwordx4 v2, s[12:15], s42 offen lds
  s_add_u32 m0, m0, 2048
  s_add_u32 s42, s42, s66
  buffer_load_dwordx4 v2, s[12:15], s42 offen lds
  s_add_u32 m0, m0, 2048
  s_add_u32 s42, s42, s66
  buffer_load_dwordx4 v2, s[12:15], s42 offen lds
  s_add_u32 m0, m0, 2048
  s_add_u32 s42, s42, s66
  buffer_load_dwordx4 v2, s[12:15], s42 offen lds
  s_add_u32 m0, m0, 2048
  s_add_u32 s42, s42, s66
  buffer_load_dwordx4 v2, s[12:15], s42 offen lds
  s_add_u32 m0, m0, 2048
  s_add_u32 s42, s42, s66
  buffer_load_dwordx4 v2, s[12:15], s42 offen lds
  s_add_u32 m0, m0, 2048
  s_add_u32 s42, s42, s66
  buffer_load_dwordx4 v2, s[12:15], s42 offen lds
  s_add_u32 m0, m0, 2048
  s_add_u32 s42, s42, s66
  buffer_load_dwordx4 v2, s[12:15], s42 offen lds
  s_add_u32 m0, m0, 2048
  s_add_u32 s42, s42, s66
  buffer_load_dwordx4 v2, s[12:15], s42 offen lds
  s_add_u32 m0, m0, 2048
  s_add_u32 s42, s42, s66
  buffer_load_dwordx4 v2, s[12:15], s42 offen lds
  s_add_u32 m0, m0, 2048
  s_add_u32 s42, s42, s66
  buffer_load_dwordx4 v2, s[12:15], s42 offen lds
  s_add_u32 m0, m0, 2048
  s_add_u32 s42, s42, s66
  buffer_load_dwordx4 v2, s[12:15], s42 offen lds
  s_add_u32 m0, m0, 2048
  s_add_u32 s42, s42, s66
  buffer_load_dwordx4 v2, s[12:15], s42 offen lds
  s_add_u32 m0, m0, 2048
  s_add_u32 s42, s42, s66
  buffer_load_dwordx4 v2, s[12:15], s42 offen lds
  s_add_u32 m0, m0, 2048
  s_add_u32 s42, s42, s66
  buffer_load_dwordx4 v2, s[12:15], s42 offen lds
  s_add_u32 m0, m0, 2048
  s_add_u32 s42, s42, s66
  buffer_load_dwordx4 v2, s[12:15], s42 offen lds
  s_add_u32 m0, m0, 2048
  s_add_u32 s42, s42, s66
  buffer_load_dwordx4 v2, s[12:15], s42 offen lds
  s_add_u32 m0, m0, 2048
  s_add_u32 s42, s42, s66
  buffer_load_dwordx4 v2, s[12:15], s42 offen lds
  s_add_u32 m0, m0, 2048
  s_add_u32 s42, s42, s66
  buffer_load_dwordx4 v2, s[12:15], s42 offen lds
  s_add_u32 m0, m0, 2048
  s_add_u32 s42, s42, s66
  buffer_load_dwordx4 v2, s[12:15], s42 offen lds
  s_add_u32 m0, m0, 2048
  s_add_u32 s42, s42, s66
  buffer_load_dwordx4 v2, s[12:15], s42 offen lds
  s_add_u32 m0, m0, 2048
  s_add_u32 s42, s42, s66
  buffer_load_dwordx4 v2, s[12:15], s42 offen lds
  s_add_u32 m0, m0, 2048
  s_add_u32 s42, s42, s66
  buffer_load_dwordx4 v2, s[12:15], s42 offen lds
  s_add_u32 m0, m0, 2048
  s_add_u32 s42, s42, s66
  buffer_load_dwordx4 v2, s[12:15], s42 offen lds
  s_add_u32 m0, m0, 2048
  s_add_u32 s42, s42, s66
  buffer_load_dwordx4 v2, s[12:15], s42 offen lds
  s_add_u32 m0, m0, 2048
  s_add_u32 s42, s42, s66
  buffer_load_dwordx4 v2, s[12:15], s42 offen lds
  s_add_u32 m0, m0, 2048
  s_add_u32 s42, s42, s66
  buffer_load_dwordx4 v2, s[12:15], s42 offen lds
  s_add_u32 m0, m0, 2048
  s_add_u32 s42, s42, s66
  buffer_load_dwordx4 v2, s[12:15], s42 offen lds
  s_branch lnqkv_kernel_lp
lnqkv_kernel_sjfin:
lnqkv_kernel_sjfin1:
  ds_read_b64_tr_b16 v[8:9], v6
  ds_read_b64_tr_b16 v[10:11], v6 offset:512
  s_mul_i32 s3, s70, 144
  s_add_u32 s3, s3, s69
  s_lshl_b32 s3, s3, 10
  s_add_u32 s3, s3, 18874368
  v_add_u32 v6, 1024, v6
  s_waitcnt lgkmcnt(0)
  buffer_store_dwordx4 v[8:11], v7, s[16:19], s3 offen sc1
  s_add_u32 s69, s69, 2
  s_sub_u32 s74, s74, 1
  s_cmp_lg_u32 s74, 0
  s_nop 0
  s_cbranch_scc1 lnqkv_kernel_sjfin1
lnqkv_kernel_fin:
lnqkv_kernel_end:
  s_endpgm
.section .rodata,"a"
.p2align 6
.amdhsa_kernel lnqkv_kernel
.amdhsa_next_free_vgpr 256
.amdhsa_next_free_sgpr 96
.amdhsa_accum_offset 256
.amdhsa_group_segment_fixed_size 0
.amdhsa_kernarg_size 80
.amdhsa_user_sgpr_count 2
.amdhsa_user_sgpr_kernarg_segment_ptr 1
.amdhsa_system_sgpr_workgroup_id_x 1
.amdhsa_float_denorm_mode_32 3
.amdhsa_ieee_mode 0
.end_amdhsa_kernel
.text
.globl parallel_sum__softmax_full_mha__dense_activation_mish__prompt_kernel
.p2align 8
.type parallel_sum__softmax_full_mha__dense_activation_mish__prompt_kernel,@function
parallel_sum__softmax_full_mha__dense_activation_mish__prompt_kernel:
  s_cmp_ge_u32 s2, 256
  s_cbranch_scc1 parallel_sum__softmax_full_mha__dense_activation_mish__prompt_kernel_end
  s_load_dwordx2 s[4:5], s[0:1], 72
  s_load_dwordx2 s[6:7], s[0:1], 0
  s_load_dwordx2 s[32:33], s[0:1], 56
  v_lshrrev_b32 v5, 6, v0
  v_and_b32 v1, 63, v0
  v_readfirstlane_b32 s16, v5
  v_lshlrev_b32 v1, 4, v1
  s_and_b32 s17, s2, 7
  s_lshr_b32 s18, s2, 3
  s_and_b32 s19, s18, 3
  s_lshl_b32 s26, s17, 2
  s_add_u32 s17, s26, s19
  s_lshr_b32 s27, s18, 2
  s_mov_b32 s34, s27
  s_lshl_b32 s23, s17, 16
  s_cmp_ge_u32 s16, 8
  s_cbranch_scc1 parallel_sum__softmax_full_mha__dense_activation_mish__prompt_kernel_G
  s_lshr_b32 s31, s16, 2
  s_and_b32 s19, s16, 3
  s_lshl_b32 s18, s27, 3
  s_lshl_b32 s19, s19, 1
  s_add_u32 s18, s18, s19
  s_lshl_b32 s24, s18, 10
  s_add_u32 s24, s24, s23
  s_lshl_b32 s35, s31, 15
  s_lshl_b32 s22, s19, 10
  s_add_u32 s22, s22, s35
  s_add_u32 s21, s23, s22
  s_add_u32 s21, s21, 2097152
  s_waitcnt lgkmcnt(0)
  s_mov_b32 s8, s4
  s_and_b32 s9, s5, 0xffff
  s_mov_b32 s10, 0x10000000
  s_mov_b32 s11, 0x00020000
  s_mov_b32 m0, s22
  s_add_u32 s25, s21, 2097152
  buffer_load_dwordx4 v1, s[8:11], s21 offen lds
  buffer_load_dwordx4 v1, s[8:11], s21 offen offset:1024 lds
  s_add_u32 m0, s22, 65536
  buffer_load_dwordx4 v[8:11], v1, s[8:11], s24 offen
  buffer_load_dwordx4 v1, s[8:11], s25 offen lds
  buffer_load_dwordx4 v1, s[8:11], s25 offen offset:1024 lds
  buffer_load_dwordx4 v[12:15], v1, s[8:11], s24 offen offset:1024
  v_lshlrev_b32 v5, 4, v0
  v_add_u32 v5, 131072, v5
  v_and_b32 v6, 11, v0
  v_cmp_eq_u32 vcc, 0, v6
  v_mov_b32 v6, 0x3f803f80
  s_nop 0
  v_cndmask_b32 v40, 0, v6, vcc
  v_mov_b32 v41, v40
  v_mov_b32 v42, v40
  v_mov_b32 v43, v40
  ds_write_b128 v5, v[40:43] offset:0
  ds_write_b128 v5, v[40:43] offset:2048
  v_add_u32 v2, s35, v1
  v_and_b32 v5, 15, v0
  v_lshlrev_b32 v5, 4, v5
  v_and_b32 v6, 32, v0
  v_lshlrev_b32 v6, 3, v6
  v_add_u32 v5, v5, v6
  s_add_u32 s36, s35, 65536
  v_add_u32 v3, s36, v5
  v_and_b32 v5, 31, v0
  v_subrev_u32 v6, 20, v5
  v_cmp_gt_u32 vcc, 8, v6
  v_mov_b32 v6, 131072
  v_mov_b32 v4, 131136
  v_cndmask_b32 v6, v6, v4, vcc
  v_and_b32 v4, 27, v0
  v_cmp_ne_u32 vcc, 16, v4
  v_add_u32 v4, 16, v6
  s_nop 0
  v_cndmask_b32 v6, v6, v4, vcc
  v_cmp_gt_u32 vcc, 16, v5
  v_mov_b32 v4, 0
  v_mov_b32 v5, 8192
  v_cndmask_b32 v3, v6, v3, vcc
  v_cndmask_b32 v4, v4, v5, vcc
  v_mov_b32 v7, 159748
  v_mov_b32 v120, 0
  v_mov_b32 v121, 0
  v_mov_b32 v122, 0
  v_mov_b32 v123, 0
  v_mov_b32 v124, 0
  v_mov_b32 v125, 0
  v_mov_b32 v126, 0
  v_mov_b32 v127, 0
  v_mov_b32 v128, 0
  v_mov_b32 v129, 0
  v_mov_b32 v130, 0
  v_mov_b32 v131, 0
  v_mov_b32 v132, 0
  v_mov_b32 v133, 0
  v_mov_b32 v134, 0
  v_mov_b32 v135, 0
  v_mov_b32 v136, 0
  v_mov_b32 v137, 0
  v_mov_b32 v138, 0
  v_mov_b32 v139, 0
  v_mov_b32 v140, 0
  v_mov_b32 v141, 0
  v_mov_b32 v142, 0
  v_mov_b32 v143, 0
  v_mov_b32 v144, 0
  v_mov_b32 v145, 0
  v_mov_b32 v146, 0
  v_mov_b32 v147, 0
  v_mov_b32 v148, 0
  v_mov_b32 v149, 0
  v_mov_b32 v150, 0
  v_mov_b32 v151, 0
  v_mov_b32 v52, 0
  v_mov_b32 v36, 0
  v_mov_b32 v53, 0
  v_mov_b32 v37, 0
  v_mov_b32 v54, 0
  v_mov_b32 v38, 0
  v_mov_b32 v55, 0
  v_mov_b32 v39, 0
  s_waitcnt vmcnt(0) lgkmcnt(0)
  s_barrier
  ds_read_b128 v[16:19], v2
  ds_read_b128 v[20:23], v2 offset:1024
  ds_read_b128 v[24:27], v3
  ds_read_b128 v[28:31], v3 offset:512
  s_mov_b32 s20, 0
  s_setprio 3
  s_waitcnt lgkmcnt(3)
  v_mfma_f32_32x32x16_bf16 v[56:71], v[16:19], v[8:11], 0
  v_mfma_f32_32x32x16_bf16 v[88:103], v[16:19], v[12:15], 0
  s_nop 15
.p2align 6
parallel_sum__softmax_full_mha__dense_activation_mish__prompt_kernel_loop:
  s_waitcnt lgkmcnt(0)
  v_mfma_f32_32x32x16_bf16 v[72:87], v[20:23], v[8:11], 0
  ds_read_b128 v[16:19], v2 offset:2048
  v_exp_f32 v56, v56
  v_exp_f32 v57, v57
  v_exp_f32 v58, v58
  v_exp_f32 v59, v59
  v_mfma_f32_32x32x16_bf16 v[136:151], v[36:39], v[52:55], v[136:151]
  ds_read_b128 v[32:35], v3 offset:1024
  ds_read_b128 v[36:39], v3 offset:1536
  v_exp_f32 v60, v60
  v_exp_f32 v61, v61
  v_exp_f32 v62, v62
  v_exp_f32 v63, v63
  v_cvt_pk_bf16_f32 v40, v56, v57
  v_cvt_pk_bf16_f32 v41, v58, v59
  v_cvt_pk_bf16_f32 v42, v60, v61
  v_cvt_pk_bf16_f32 v43, v62, v63
  v_mfma_f32_32x32x16_bf16 v[104:119], v[20:23], v[12:15], 0
  v_exp_f32 v64, v64
  v_exp_f32 v65, v65
  v_exp_f32 v66, v66
  v_exp_f32 v67, v67
  v_mfma_f32_32x32x16_bf16 v[120:135], v[24:27], v[40:43], v[120:135]
  v_exp_f32 v68, v68
  v_exp_f32 v69, v69
  v_exp_f32 v70, v70
  v_exp_f32 v71, v71
  v_cvt_pk_bf16_f32 v44, v64, v65
  v_cvt_pk_bf16_f32 v45, v66, v67
  v_cvt_pk_bf16_f32 v46, v68, v69
  v_cvt_pk_bf16_f32 v47, v70, v71
  v_exp_f32 v88, v88
  v_exp_f32 v89, v89
  v_exp_f32 v90, v90
  v_exp_f32 v91, v91
  v_mfma_f32_32x32x16_bf16 v[120:135], v[28:31], v[44:47], v[120:135]
  v_exp_f32 v92, v92
  v_exp_f32 v93, v93
  v_exp_f32 v94, v94
  v_exp_f32 v95, v95
  v_cvt_pk_bf16_f32 v48, v88, v89
  v_cvt_pk_bf16_f32 v49, v90, v91
  v_cvt_pk_bf16_f32 v50, v92, v93
  v_cvt_pk_bf16_f32 v51, v94, v95
  v_exp_f32 v96, v96
  v_exp_f32 v97, v97
  v_exp_f32 v98, v98
  v_exp_f32 v99, v99
  v_mfma_f32_32x32x16_bf16 v[136:151], v[24:27], v[48:51], v[136:151]
  v_exp_f32 v100, v100
  v_exp_f32 v101, v101
  v_exp_f32 v102, v102
  v_exp_f32 v103, v103
  v_cvt_pk_bf16_f32 v52, v96, v97
  v_cvt_pk_bf16_f32 v53, v98, v99
  v_cvt_pk_bf16_f32 v54, v100, v101
  v_cvt_pk_bf16_f32 v55, v102, v103
  s_waitcnt lgkmcnt(0)
  v_mfma_f32_32x32x16_bf16 v[56:71], v[16:19], v[8:11], 0
  ds_read_b128 v[20:23], v2 offset:3072
  v_exp_f32 v72, v72
  v_exp_f32 v73, v73
  v_exp_f32 v74, v74
  v_exp_f32 v75, v75
  v_mfma_f32_32x32x16_bf16 v[136:151], v[28:31], v[52:55], v[136:151]
  ds_read_b128 v[24:27], v3 offset:2048
  ds_read_b128 v[28:31], v3 offset:2560
  v_exp_f32 v76, v76
  v_exp_f32 v77, v77
  v_exp_f32 v78, v78
  v_exp_f32 v79, v79
  v_cvt_pk_bf16_f32 v40, v72, v73
  v_cvt_pk_bf16_f32 v41, v74, v75
  v_cvt_pk_bf16_f32 v42, v76, v77
  v_cvt_pk_bf16_f32 v43, v78, v79
  v_mfma_f32_32x32x16_bf16 v[88:103], v[16:19], v[12:15], 0
  v_exp_f32 v80, v80
  v_exp_f32 v81, v81
  v_exp_f32 v82, v82
  v_exp_f32 v83, v83
  v_mfma_f32_32x32x16_bf16 v[120:135], v[32:35], v[40:43], v[120:135]
  v_exp_f32 v84, v84
  v_exp_f32 v85, v85
  v_exp_f32 v86, v86
  v_exp_f32 v87, v87
  v_cvt_pk_bf16_f32 v44, v80, v81
  v_cvt_pk_bf16_f32 v45, v82, v83
  v_cvt_pk_bf16_f32 v46, v84, v85
  v_cvt_pk_bf16_f32 v47, v86, v87
  v_exp_f32 v104, v104
  v_exp_f32 v105, v105
  v_exp_f32 v106, v106
  v_exp_f32 v107, v107
  v_mfma_f32_32x32x16_bf16 v[120:135], v[36:39], v[44:47], v[120:135]
  v_exp_f32 v108, v108
  v_exp_f32 v109, v109
  v_exp_f32 v110, v110
  v_exp_f32 v111, v111
  v_cvt_pk_bf16_f32 v48, v104, v105
  v_cvt_pk_bf16_f32 v49, v106, v107
  v_cvt_pk_bf16_f32 v50, v108, v109
  v_cvt_pk_bf16_f32 v51, v110, v111
  v_exp_f32 v112, v112
  v_exp_f32 v113, v113
  v_exp_f32 v114, v114
  v_exp_f32 v115, v115
  v_mfma_f32_32x32x16_bf16 v[136:151], v[32:35], v[48:51], v[136:151]
  v_exp_f32 v116, v116
  v_exp_f32 v117, v117
  v_exp_f32 v118, v118
  v_exp_f32 v119, v119
  v_cvt_pk_bf16_f32 v52, v112, v113
  v_cvt_pk_bf16_f32 v53, v114, v115
  v_cvt_pk_bf16_f32 v54, v116, v117
  v_cvt_pk_bf16_f32 v55, v118, v119
  s_waitcnt lgkmcnt(0)
  v_mfma_f32_32x32x16_bf16 v[72:87], v[20:23], v[8:11], 0
  ds_read_b128 v[16:19], v2 offset:4096
  v_exp_f32 v56, v56
  v_exp_f32 v57, v57
  v_exp_f32 v58, v58
  v_exp_f32 v59, v59
  v_mfma_f32_32x32x16_bf16 v[136:151], v[36:39], v[52:55], v[136:151]
  ds_read_b128 v[32:35], v3 offset:3072
  ds_read_b128 v[36:39], v3 offset:3584
  v_exp_f32 v60, v60
  v_exp_f32 v61, v61
  v_exp_f32 v62, v62
  v_exp_f32 v63, v63
  v_cvt_pk_bf16_f32 v40, v56, v57
  v_cvt_pk_bf16_f32 v41, v58, v59
  v_cvt_pk_bf16_f32 v42, v60, v61
  v_cvt_pk_bf16_f32 v43, v62, v63
  v_mfma_f32_32x32x16_bf16 v[104:119], v[20:23], v[12:15], 0
  v_exp_f32 v64, v64
  v_exp_f32 v65, v65
  v_exp_f32 v66, v66
  v_exp_f32 v67, v67
  v_mfma_f32_32x32x16_bf16 v[120:135], v[24:27], v[40:43], v[120:135]
  v_exp_f32 v68, v68
  v_exp_f32 v69, v69
  v_exp_f32 v70, v70
  v_exp_f32 v71, v71
  v_cvt_pk_bf16_f32 v44, v64, v65
  v_cvt_pk_bf16_f32 v45, v66, v67
  v_cvt_pk_bf16_f32 v46, v68, v69
  v_cvt_pk_bf16_f32 v47, v70, v71
  v_exp_f32 v88, v88
  v_exp_f32 v89, v89
  v_exp_f32 v90, v90
  v_exp_f32 v91, v91
  v_mfma_f32_32x32x16_bf16 v[120:135], v[28:31], v[44:47], v[120:135]
  v_exp_f32 v92, v92
  v_exp_f32 v93, v93
  v_exp_f32 v94, v94
  v_exp_f32 v95, v95
  v_cvt_pk_bf16_f32 v48, v88, v89
  v_cvt_pk_bf16_f32 v49, v90, v91
  v_cvt_pk_bf16_f32 v50, v92, v93
  v_cvt_pk_bf16_f32 v51, v94, v95
  v_exp_f32 v96, v96
  v_exp_f32 v97, v97
  v_exp_f32 v98, v98
  v_exp_f32 v99, v99
  v_mfma_f32_32x32x16_bf16 v[136:151], v[24:27], v[48:51], v[136:151]
  v_exp_f32 v100, v100
  v_exp_f32 v101, v101
  v_exp_f32 v102, v102
  v_exp_f32 v103, v103
  v_cvt_pk_bf16_f32 v52, v96, v97
  v_cvt_pk_bf16_f32 v53, v98, v99
  v_cvt_pk_bf16_f32 v54, v100, v101
  v_cvt_pk_bf16_f32 v55, v102, v103
  s_waitcnt lgkmcnt(0)
  v_mfma_f32_32x32x16_bf16 v[56:71], v[16:19], v[8:11], 0
  ds_read_b128 v[20:23], v2 offset:5120
  v_exp_f32 v72, v72
  v_exp_f32 v73, v73
  v_exp_f32 v74, v74
  v_exp_f32 v75, v75
  v_mfma_f32_32x32x16_bf16 v[136:151], v[28:31], v[52:55], v[136:151]
  ds_read_b128 v[24:27], v3 offset:4096
  ds_read_b128 v[28:31], v3 offset:4608
  v_exp_f32 v76, v76
  v_exp_f32 v77, v77
  v_exp_f32 v78, v78
  v_exp_f32 v79, v79
  v_cvt_pk_bf16_f32 v40, v72, v73
  v_cvt_pk_bf16_f32 v41, v74, v75
  v_cvt_pk_bf16_f32 v42, v76, v77
  v_cvt_pk_bf16_f32 v43, v78, v79
  v_mfma_f32_32x32x16_bf16 v[88:103], v[16:19], v[12:15], 0
  v_exp_f32 v80, v80
  v_exp_f32 v81, v81
  v_exp_f32 v82, v82
  v_exp_f32 v83, v83
  v_mfma_f32_32x32x16_bf16 v[120:135], v[32:35], v[40:43], v[120:135]
  v_exp_f32 v84, v84
  v_exp_f32 v85, v85
  v_exp_f32 v86, v86
  v_exp_f32 v87, v87
  v_cvt_pk_bf16_f32 v44, v80, v81
  v_cvt_pk_bf16_f32 v45, v82, v83
  v_cvt_pk_bf16_f32 v46, v84, v85
  v_cvt_pk_bf16_f32 v47, v86, v87
  v_exp_f32 v104, v104
  v_exp_f32 v105, v105
  v_exp_f32 v106, v106
  v_exp_f32 v107, v107
  v_mfma_f32_32x32x16_bf16 v[120:135], v[36:39], v[44:47], v[120:135]
  v_exp_f32 v108, v108
  v_exp_f32 v109, v109
  v_exp_f32 v110, v110
  v_exp_f32 v111, v111
  v_cvt_pk_bf16_f32 v48, v104, v105
  v_cvt_pk_bf16_f32 v49, v106, v107
  v_cvt_pk_bf16_f32 v50, v108, v109
  v_cvt_pk_bf16_f32 v51, v110, v111
  v_exp_f32 v112, v112
  v_exp_f32 v113, v113
  v_exp_f32 v114, v114
  v_exp_f32 v115, v115
  v_mfma_f32_32x32x16_bf16 v[136:151], v[32:35], v[48:51], v[136:151]
  v_exp_f32 v116, v116
  v_exp_f32 v117, v117
  v_exp_f32 v118, v118
  v_exp_f32 v119, v119
  v_cvt_pk_bf16_f32 v52, v112, v113
  v_cvt_pk_bf16_f32 v53, v114, v115
  v_cvt_pk_bf16_f32 v54, v116, v117
  v_cvt_pk_bf16_f32 v55, v118, v119
  s_waitcnt lgkmcnt(0)
  v_mfma_f32_32x32x16_bf16 v[72:87], v[20:23], v[8:11], 0
  ds_read_b128 v[16:19], v2 offset:6144
  v_exp_f32 v56, v56
  v_exp_f32 v57, v57
  v_exp_f32 v58, v58
  v_exp_f32 v59, v59
  v_mfma_f32_32x32x16_bf16 v[136:151], v[36:39], v[52:55], v[136:151]
  ds_read_b128 v[32:35], v3 offset:5120
  ds_read_b128 v[36:39], v3 offset:5632
  v_exp_f32 v60, v60
  v_exp_f32 v61, v61
  v_exp_f32 v62, v62
  v_exp_f32 v63, v63
  v_cvt_pk_bf16_f32 v40, v56, v57
  v_cvt_pk_bf16_f32 v41, v58, v59
  v_cvt_pk_bf16_f32 v42, v60, v61
  v_cvt_pk_bf16_f32 v43, v62, v63
  v_mfma_f32_32x32x16_bf16 v[104:119], v[20:23], v[12:15], 0
  v_exp_f32 v64, v64
  v_exp_f32 v65, v65
  v_exp_f32 v66, v66
  v_exp_f32 v67, v67
  v_mfma_f32_32x32x16_bf16 v[120:135], v[24:27], v[40:43], v[120:135]
  v_exp_f32 v68, v68
  v_exp_f32 v69, v69
  v_exp_f32 v70, v70
  v_exp_f32 v71, v71
  v_cvt_pk_bf16_f32 v44, v64, v65
  v_cvt_pk_bf16_f32 v45, v66, v67
  v_cvt_pk_bf16_f32 v46, v68, v69
  v_cvt_pk_bf16_f32 v47, v70, v71
  v_exp_f32 v88, v88
  v_exp_f32 v89, v89
  v_exp_f32 v90, v90
  v_exp_f32 v91, v91
  v_mfma_f32_32x32x16_bf16 v[120:135], v[28:31], v[44:47], v[120:135]
  v_exp_f32 v92, v92
  v_exp_f32 v93, v93
  v_exp_f32 v94, v94
  v_exp_f32 v95, v95
  v_cvt_pk_bf16_f32 v48, v88, v89
  v_cvt_pk_bf16_f32 v49, v90, v91
  v_cvt_pk_bf16_f32 v50, v92, v93
  v_cvt_pk_bf16_f32 v51, v94, v95
  v_exp_f32 v96, v96
  v_exp_f32 v97, v97
  v_exp_f32 v98, v98
  v_exp_f32 v99, v99
  v_mfma_f32_32x32x16_bf16 v[136:151], v[24:27], v[48:51], v[136:151]
  v_exp_f32 v100, v100
  v_exp_f32 v101, v101
  v_exp_f32 v102, v102
  v_exp_f32 v103, v103
  v_cvt_pk_bf16_f32 v52, v96, v97
  v_cvt_pk_bf16_f32 v53, v98, v99
  v_cvt_pk_bf16_f32 v54, v100, v101
  v_cvt_pk_bf16_f32 v55, v102, v103
  s_waitcnt lgkmcnt(0)
  v_mfma_f32_32x32x16_bf16 v[56:71], v[16:19], v[8:11], 0
  ds_read_b128 v[20:23], v2 offset:7168
  v_exp_f32 v72, v72
  v_exp_f32 v73, v73
  v_exp_f32 v74, v74
  v_exp_f32 v75, v75
  v_mfma_f32_32x32x16_bf16 v[136:151], v[28:31], v[52:55], v[136:151]
  ds_read_b128 v[24:27], v3 offset:6144
  ds_read_b128 v[28:31], v3 offset:6656
  ds_read_b32 v5, v7
  v_exp_f32 v76, v76
  v_exp_f32 v77, v77
  v_exp_f32 v78, v78
  v_exp_f32 v79, v79
  v_cvt_pk_bf16_f32 v40, v72, v73
  v_cvt_pk_bf16_f32 v41, v74, v75
  v_cvt_pk_bf16_f32 v42, v76, v77
  v_cvt_pk_bf16_f32 v43, v78, v79
  v_mfma_f32_32x32x16_bf16 v[88:103], v[16:19], v[12:15], 0
  v_exp_f32 v80, v80
  v_exp_f32 v81, v81
  v_exp_f32 v82, v82
  v_exp_f32 v83, v83
  v_mfma_f32_32x32x16_bf16 v[120:135], v[32:35], v[40:43], v[120:135]
  v_exp_f32 v84, v84
  v_exp_f32 v85, v85
  v_exp_f32 v86, v86
  v_exp_f32 v87, v87
  v_cvt_pk_bf16_f32 v44, v80, v81
  v_cvt_pk_bf16_f32 v45, v82, v83
  v_cvt_pk_bf16_f32 v46, v84, v85
  v_cvt_pk_bf16_f32 v47, v86, v87
  v_exp_f32 v104, v104
  v_exp_f32 v105, v105
  v_exp_f32 v106, v106
  v_exp_f32 v107, v107
  v_mfma_f32_32x32x16_bf16 v[120:135], v[36:39], v[44:47], v[120:135]
  v_exp_f32 v108, v108
  v_exp_f32 v109, v109
  v_exp_f32 v110, v110
  v_exp_f32 v111, v111
  v_cvt_pk_bf16_f32 v48, v104, v105
  v_cvt_pk_bf16_f32 v49, v106, v107
  v_cvt_pk_bf16_f32 v50, v108, v109
  v_cvt_pk_bf16_f32 v51, v110, v111
  v_exp_f32 v112, v112
  v_exp_f32 v113, v113
  v_exp_f32 v114, v114
  v_exp_f32 v115, v115
  v_mfma_f32_32x32x16_bf16 v[136:151], v[32:35], v[48:51], v[136:151]
  v_exp_f32 v116, v116
  v_exp_f32 v117, v117
  v_exp_f32 v118, v118
  v_exp_f32 v119, v119
  v_cvt_pk_bf16_f32 v52, v112, v113
  v_cvt_pk_bf16_f32 v53, v114, v115
  v_cvt_pk_bf16_f32 v54, v116, v117
  v_cvt_pk_bf16_f32 v55, v118, v119
  s_waitcnt lgkmcnt(0)
  v_mfma_f32_32x32x16_bf16 v[72:87], v[20:23], v[8:11], 0
  v_readfirstlane_b32 s28, v5
  s_nop 0
  s_cmp_lt_u32 s28, 4
  s_cbranch_scc1 parallel_sum__softmax_full_mha__dense_activation_mish__prompt_kernel_spin
parallel_sum__softmax_full_mha__dense_activation_mish__prompt_kernel_spinret:
  ds_read_b128 v[16:19], v2 offset:8192
  v_exp_f32 v56, v56
  v_exp_f32 v57, v57
  v_exp_f32 v58, v58
  v_exp_f32 v59, v59
  v_mfma_f32_32x32x16_bf16 v[136:151], v[36:39], v[52:55], v[136:151]
  ds_read_b128 v[32:35], v3 offset:7168
  ds_read_b128 v[36:39], v3 offset:7680
  v_exp_f32 v60, v60
  v_exp_f32 v61, v61
  v_exp_f32 v62, v62
  v_exp_f32 v63, v63
  v_cvt_pk_bf16_f32 v40, v56, v57
  v_cvt_pk_bf16_f32 v41, v58, v59
  v_cvt_pk_bf16_f32 v42, v60, v61
  v_cvt_pk_bf16_f32 v43, v62, v63
  v_mfma_f32_32x32x16_bf16 v[104:119], v[20:23], v[12:15], 0
  v_exp_f32 v64, v64
  v_exp_f32 v65, v65
  v_exp_f32 v66, v66
  v_exp_f32 v67, v67
  v_mfma_f32_32x32x16_bf16 v[120:135], v[24:27], v[40:43], v[120:135]
  v_exp_f32 v68, v68
  v_exp_f32 v69, v69
  v_exp_f32 v70, v70
  v_exp_f32 v71, v71
  v_cvt_pk_bf16_f32 v44, v64, v65
  v_cvt_pk_bf16_f32 v45, v66, v67
  v_cvt_pk_bf16_f32 v46, v68, v69
  v_cvt_pk_bf16_f32 v47, v70, v71
  v_exp_f32 v88, v88
  v_exp_f32 v89, v89
  v_exp_f32 v90, v90
  v_exp_f32 v91, v91
  v_mfma_f32_32x32x16_bf16 v[120:135], v[28:31], v[44:47], v[120:135]
  v_exp_f32 v92, v92
  v_exp_f32 v93, v93
  v_exp_f32 v94, v94
  v_exp_f32 v95, v95
  v_cvt_pk_bf16_f32 v48, v88, v89
  v_cvt_pk_bf16_f32 v49, v90, v91
  v_cvt_pk_bf16_f32 v50, v92, v93
  v_cvt_pk_bf16_f32 v51, v94, v95
  v_exp_f32 v96, v96
  v_exp_f32 v97, v97
  v_exp_f32 v98, v98
  v_exp_f32 v99, v99
  v_mfma_f32_32x32x16_bf16 v[136:151], v[24:27], v[48:51], v[136:151]
  v_exp_f32 v100, v100
  v_exp_f32 v101, v101
  v_exp_f32 v102, v102
  v_exp_f32 v103, v103
  v_cvt_pk_bf16_f32 v52, v96, v97
  v_cvt_pk_bf16_f32 v53, v98, v99
  v_cvt_pk_bf16_f32 v54, v100, v101
  v_cvt_pk_bf16_f32 v55, v102, v103
  s_waitcnt lgkmcnt(0)
  v_mfma_f32_32x32x16_bf16 v[56:71], v[16:19], v[8:11], 0
  ds_read_b128 v[20:23], v2 offset:9216
  v_exp_f32 v72, v72
  v_exp_f32 v73, v73
  v_exp_f32 v74, v74
  v_exp_f32 v75, v75
  v_mfma_f32_32x32x16_bf16 v[136:151], v[28:31], v[52:55], v[136:151]
  ds_read_b128 v[24:27], v3 offset:8192
  ds_read_b128 v[28:31], v3 offset:8704
  v_exp_f32 v76, v76
  v_exp_f32 v77, v77
  v_exp_f32 v78, v78
  v_exp_f32 v79, v79
  v_cvt_pk_bf16_f32 v40, v72, v73
  v_cvt_pk_bf16_f32 v41, v74, v75
  v_cvt_pk_bf16_f32 v42, v76, v77
  v_cvt_pk_bf16_f32 v43, v78, v79
  v_mfma_f32_32x32x16_bf16 v[88:103], v[16:19], v[12:15], 0
  v_exp_f32 v80, v80
  v_exp_f32 v81, v81
  v_exp_f32 v82, v82
  v_exp_f32 v83, v83
  v_mfma_f32_32x32x16_bf16 v[120:135], v[32:35], v[40:43], v[120:135]
  v_exp_f32 v84, v84
  v_exp_f32 v85, v85
  v_exp_f32 v86, v86
  v_exp_f32 v87, v87
  v_cvt_pk_bf16_f32 v44, v80, v81
  v_cvt_pk_bf16_f32 v45, v82, v83
  v_cvt_pk_bf16_f32 v46, v84, v85
  v_cvt_pk_bf16_f32 v47, v86, v87
  v_exp_f32 v104, v104
  v_exp_f32 v105, v105
  v_exp_f32 v106, v106
  v_exp_f32 v107, v107
  v_mfma_f32_32x32x16_bf16 v[120:135], v[36:39], v[44:47], v[120:135]
  v_exp_f32 v108, v108
  v_exp_f32 v109, v109
  v_exp_f32 v110, v110
  v_exp_f32 v111, v111
  v_cvt_pk_bf16_f32 v48, v104, v105
  v_cvt_pk_bf16_f32 v49, v106, v107
  v_cvt_pk_bf16_f32 v50, v108, v109
  v_cvt_pk_bf16_f32 v51, v110, v111
  v_exp_f32 v112, v112
  v_exp_f32 v113, v113
  v_exp_f32 v114, v114
  v_exp_f32 v115, v115
  v_mfma_f32_32x32x16_bf16 v[136:151], v[32:35], v[48:51], v[136:151]
  v_exp_f32 v116, v116
  v_exp_f32 v117, v117
  v_exp_f32 v118, v118
  v_exp_f32 v119, v119
  v_cvt_pk_bf16_f32 v52, v112, v113
  v_cvt_pk_bf16_f32 v53, v114, v115
  v_cvt_pk_bf16_f32 v54, v116, v117
  v_cvt_pk_bf16_f32 v55, v118, v119
  v_add_u32 v2, 8192, v2
  v_add_u32 v3, v4, v3
  v_add_u32 v7, 4, v7
  s_add_u32 s20, s20, 1
  s_cmp_eq_u32 s20, 1
  s_cbranch_scc0 parallel_sum__softmax_full_mha__dense_activation_mish__prompt_kernel_lv1
  s_setprio 2
parallel_sum__softmax_full_mha__dense_activation_mish__prompt_kernel_lv1:
  s_cmp_eq_u32 s20, 2
  s_cbranch_scc0 parallel_sum__softmax_full_mha__dense_activation_mish__prompt_kernel_lv2
  s_setprio 1
parallel_sum__softmax_full_mha__dense_activation_mish__prompt_kernel_lv2:
  s_cmp_eq_u32 s20, 3
  s_cbranch_scc0 parallel_sum__softmax_full_mha__dense_activation_mish__prompt_kernel_lv3
  s_setprio 0
parallel_sum__softmax_full_mha__dense_activation_mish__prompt_kernel_lv3:
  s_cmp_lt_u32 s20, 4
  s_cbranch_scc1 parallel_sum__softmax_full_mha__dense_activation_mish__prompt_kernel_loop
  s_waitcnt lgkmcnt(0)
  v_mfma_f32_32x32x16_bf16 v[136:151], v[36:39], v[52:55], v[136:151]
  s_mul_i32 s26, s16, 2304
  s_add_u32 s26, s26, 141312
  s_xor_b32 s28, s16, 4
  s_mul_i32 s28, s28, 2304
  s_add_u32 s28, s28, 141312
  v_add_u32 v5, s26, v1
  v_lshrrev_b32 v6, 2, v1
  v_add_u32 v7, s26, v6
  v_add_u32 v2, s28, v1
  v_add_u32 v6, s28, v6
  s_nop 7
  s_cmp_eq_u32 s31, 0
  s_cbranch_scc0 parallel_sum__softmax_full_mha__dense_activation_mish__prompt_kernel_x1
parallel_sum__softmax_full_mha__dense_activation_mish__prompt_kernel_x0:
  ds_write_b128 v5, v[136:139]
  ds_write_b128 v5, v[140:143] offset:1024
  ds_write_b32 v7, v144 offset:2048
  s_waitcnt lgkmcnt(0)
  s_barrier
  ds_read_b128 v[136:139], v2
  ds_read_b128 v[140:143], v2 offset:1024
  ds_read_b32 v144, v6 offset:2048
  s_waitcnt lgkmcnt(0)
  v_add_f32 v120, v120, v136
  v_add_f32 v121, v121, v137
  v_add_f32 v122, v122, v138
  v_add_f32 v123, v123, v139
  v_add_f32 v124, v124, v140
  v_add_f32 v125, v125, v141
  v_add_f32 v126, v126, v142
  v_add_f32 v127, v127, v143
  v_add_f32 v128, v128, v144
  v_mul_f32 v5, 0, v120
  v_fmac_f32 v5, 0, v121
  v_fmac_f32 v5, 0, v122
  v_fmac_f32 v5, 0, v123
  v_fmac_f32 v5, 0, v124
  v_fmac_f32 v5, 0, v125
  v_fmac_f32 v5, 0, v126
  v_fmac_f32 v5, 0, v127
  v_add_f32 v5, v5, v128
  s_mov_b32 s26, 0x21800000
  s_mov_b32 s27, 0x5d800000
  v_cmp_le_f32 s[28:29], s26, v5
  v_cmp_ge_f32 vcc, s27, v5
  s_nop 1
  s_and_b64 s[28:29], s[28:29], vcc
  s_cmp_eq_u64 s[28:29], exec
  s_cbranch_scc0 parallel_sum__softmax_full_mha__dense_activation_mish__prompt_kernel_slow0
parallel_sum__softmax_full_mha__dense_activation_mish__prompt_kernel_fin0:
  v_rcp_f32 v5, v128
  s_add_u32 s24, s18, 0
  s_mul_i32 s24, s24, 144
  s_add_u32 s24, s24, s17
  s_lshl_b32 s24, s24, 10
  s_add_u32 s24, s24, 8388608
  v_mul_f32 v120, v120, v5
  v_mul_f32 v121, v121, v5
  v_mul_f32 v122, v122, v5
  v_mul_f32 v123, v123, v5
  v_mul_f32 v124, v124, v5
  v_mul_f32 v125, v125, v5
  v_mul_f32 v126, v126, v5
  v_mul_f32 v127, v127, v5
  v_cvt_pk_bf16_f32 v40, v120, v121
  v_cvt_pk_bf16_f32 v41, v122, v123
  v_cvt_pk_bf16_f32 v42, v124, v125
  v_cvt_pk_bf16_f32 v43, v126, v127
  v_add_u32 v6, s24, v1
  global_store_dwordx4 v6, v[40:43], s[4:5] sc1
  s_branch parallel_sum__softmax_full_mha__dense_activation_mish__prompt_kernel_pub
parallel_sum__softmax_full_mha__dense_activation_mish__prompt_kernel_x1:
  ds_write_b128 v5, v[120:123]
  ds_write_b128 v5, v[124:127] offset:1024
  ds_write_b32 v7, v128 offset:2048
  s_waitcnt lgkmcnt(0)
  s_barrier
  ds_read_b128 v[120:123], v2
  ds_read_b128 v[124:127], v2 offset:1024
  ds_read_b32 v128, v6 offset:2048
  s_waitcnt lgkmcnt(0)
  v_add_f32 v136, v136, v120
  v_add_f32 v137, v137, v121
  v_add_f32 v138, v138, v122
  v_add_f32 v139, v139, v123
  v_add_f32 v140, v140, v124
  v_add_f32 v141, v141, v125
  v_add_f32 v142, v142, v126
  v_add_f32 v143, v143, v127
  v_add_f32 v144, v144, v128
  v_mul_f32 v5, 0, v136
  v_fmac_f32 v5, 0, v137
  v_fmac_f32 v5, 0, v138
  v_fmac_f32 v5, 0, v139
  v_fmac_f32 v5, 0, v140
  v_fmac_f32 v5, 0, v141
  v_fmac_f32 v5, 0, v142
  v_fmac_f32 v5, 0, v143
  v_add_f32 v5, v5, v144
  s_mov_b32 s26, 0x21800000
  s_mov_b32 s27, 0x5d800000
  v_cmp_le_f32 s[28:29], s26, v5
  v_cmp_ge_f32 vcc, s27, v5
  s_nop 1
  s_and_b64 s[28:29], s[28:29], vcc
  s_cmp_eq_u64 s[28:29], exec
  s_cbranch_scc0 parallel_sum__softmax_full_mha__dense_activation_mish__prompt_kernel_slow1
parallel_sum__softmax_full_mha__dense_activation_mish__prompt_kernel_fin1:
  v_rcp_f32 v5, v144
  s_add_u32 s24, s18, 1
  s_mul_i32 s24, s24, 144
  s_add_u32 s24, s24, s17
  s_lshl_b32 s24, s24, 10
  s_add_u32 s24, s24, 8388608
  v_mul_f32 v136, v136, v5
  v_mul_f32 v137, v137, v5
  v_mul_f32 v138, v138, v5
  v_mul_f32 v139, v139, v5
  v_mul_f32 v140, v140, v5
  v_mul_f32 v141, v141, v5
  v_mul_f32 v142, v142, v5
  v_mul_f32 v143, v143, v5
  v_cvt_pk_bf16_f32 v48, v136, v137
  v_cvt_pk_bf16_f32 v49, v138, v139
  v_cvt_pk_bf16_f32 v50, v140, v141
  v_cvt_pk_bf16_f32 v51, v142, v143
  v_add_u32 v6, s24, v1
  global_store_dwordx4 v6, v[48:51], s[4:5] sc1
parallel_sum__softmax_full_mha__dense_activation_mish__prompt_kernel_pub:
  v_mov_b32 v5, 159776
  v_mov_b32 v6, 1
  s_waitcnt vmcnt(0)
  s_mov_b64 exec, 1
  ds_add_rtn_u32 v2, v5, v6
  s_lshl_b32 s24, s34, 2
  s_lshr_b32 s26, s17, 3
  s_add_u32 s24, s24, s26
  s_lshl_b32 s24, s24, 7
  s_add_u32 s24, s24, 27262976
  v_mov_b32 v5, s24
  s_waitcnt lgkmcnt(0)
  v_readfirstlane_b32 s28, v2
  s_nop 0
  s_cmp_lg_u32 s28, 7
  s_cbranch_scc1 parallel_sum__softmax_full_mha__dense_activation_mish__prompt_kernel_nosig0
  global_atomic_add v5, v6, s[4:5] sc1
parallel_sum__softmax_full_mha__dense_activation_mish__prompt_kernel_nosig0:
  s_mov_b64 exec, -1
  s_barrier
parallel_sum__softmax_full_mha__dense_activation_mish__prompt_kernel_nosig:
  s_mov_b32 s12, s6
  s_and_b32 s13, s7, 0xffff
  s_mov_b32 s14, 0x200000
  s_mov_b32 s15, 0x00020000
  s_mov_b32 s36, s32
  s_and_b32 s37, s33, 0xffff
  s_mov_b32 s38, 0x200000
  s_mov_b32 s39, 0x00020000
  v_lshrrev_b32 v5, 3, v0
  v_lshlrev_b32 v5, 10, v5
  v_and_b32 v6, 7, v0
  v_lshlrev_b32 v6, 4, v6
  v_add_u32 v7, v5, v6
  s_lshl_b32 s25, s17, 16
  s_lshl_b32 s26, s34, 7
  s_add_u32 s25, s25, s26
  buffer_load_dwordx4 v[8:11], v7, s[12:15], s25 offen
  v_lshrrev_b32 v5, 3, v0
  v_mul_u32_u24 v5, 272, v5
  v_and_b32 v6, 7, v0
  v_lshlrev_b32 v6, 5, v6
  v_add_u32 v6, v5, v6
  s_barrier
  ds_read_b128 v[80:83], v6 offset:0
  ds_read_b128 v[84:87], v6 offset:16
  ds_read_b128 v[88:91], v6 offset:17408
  ds_read_b128 v[92:95], v6 offset:17424
  ds_read_b128 v[96:99], v6 offset:34816
  ds_read_b128 v[100:103], v6 offset:34832
  ds_read_b128 v[104:107], v6 offset:52224
  ds_read_b128 v[108:111], v6 offset:52240
  s_waitcnt vmcnt(0)
  v_lshlrev_b32 v16, 16, v8
  v_and_b32 v17, 0xffff0000, v8
  v_lshlrev_b32 v18, 16, v9
  v_and_b32 v19, 0xffff0000, v9
  v_lshlrev_b32 v20, 16, v10
  v_and_b32 v21, 0xffff0000, v10
  v_lshlrev_b32 v22, 16, v11
  v_and_b32 v23, 0xffff0000, v11
  s_waitcnt lgkmcnt(6)
  v_add_f32 v16, v16, v80
  v_add_f32 v17, v17, v81
  v_add_f32 v18, v18, v82
  v_add_f32 v19, v19, v83
  v_add_f32 v20, v20, v84
  v_add_f32 v21, v21, v85
  v_add_f32 v22, v22, v86
  v_add_f32 v23, v23, v87
  s_waitcnt lgkmcnt(4)
  v_add_f32 v16, v16, v88
  v_add_f32 v17, v17, v89
  v_add_f32 v18, v18, v90
  v_add_f32 v19, v19, v91
  v_add_f32 v20, v20, v92
  v_add_f32 v21, v21, v93
  v_add_f32 v22, v22, v94
  v_add_f32 v23, v23, v95
  s_waitcnt lgkmcnt(2)
  v_add_f32 v16, v16, v96
  v_add_f32 v17, v17, v97
  v_add_f32 v18, v18, v98
  v_add_f32 v19, v19, v99
  v_add_f32 v20, v20, v100
  v_add_f32 v21, v21, v101
  v_add_f32 v22, v22, v102
  v_add_f32 v23, v23, v103
  s_waitcnt lgkmcnt(0)
  v_add_f32 v16, v16, v104
  v_add_f32 v17, v17, v105
  v_add_f32 v18, v18, v106
  v_add_f32 v19, v19, v107
  v_add_f32 v20, v20, v108
  v_add_f32 v21, v21, v109
  v_add_f32 v22, v22, v110
  v_add_f32 v23, v23, v111
  v_cvt_pk_bf16_f32 v32, v16, v17
  v_cvt_pk_bf16_f32 v33, v18, v19
  v_cvt_pk_bf16_f32 v34, v20, v21
  v_cvt_pk_bf16_f32 v35, v22, v23
  buffer_store_dwordx4 v[32:35], v7, s[36:39], s25 offen
parallel_sum__softmax_full_mha__dense_activation_mish__prompt_kernel_done:
parallel_sum__softmax_full_mha__dense_activation_mish__prompt_kernel_end:
  s_endpgm
parallel_sum__softmax_full_mha__dense_activation_mish__prompt_kernel_spin:
  ds_read_b32 v5, v7
  s_waitcnt lgkmcnt(0)
  v_readfirstlane_b32 s28, v5
  s_nop 0
  s_cmp_lt_u32 s28, 4
  s_cbranch_scc1 parallel_sum__softmax_full_mha__dense_activation_mish__prompt_kernel_spin
  s_branch parallel_sum__softmax_full_mha__dense_activation_mish__prompt_kernel_spinret
parallel_sum__softmax_full_mha__dense_activation_mish__prompt_kernel_slow0:
  v_mov_b32 v2, v1
  v_mov_b32 v5, 0xff800000
  s_mov_b32 s20, 0
parallel_sum__softmax_full_mha__dense_activation_mish__prompt_kernel_slow0a:
  ds_read_b128 v[16:19], v2
  v_add_u32 v2, 1024, v2
  s_waitcnt lgkmcnt(0)
  v_mfma_f32_32x32x16_bf16 v[56:71], v[16:19], v[8:11], 0
  s_nop 15
  v_max3_f32 v5, v5, v56, v57
  v_max3_f32 v5, v5, v58, v59
  v_max3_f32 v5, v5, v60, v61
  v_max3_f32 v5, v5, v62, v63
  v_max3_f32 v5, v5, v64, v65
  v_max3_f32 v5, v5, v66, v67
  v_max3_f32 v5, v5, v68, v69
  v_max3_f32 v5, v5, v70, v71
  s_add_u32 s20, s20, 1
  s_cmp_lt_u32 s20, 64
  s_cbranch_scc1 parallel_sum__softmax_full_mha__dense_activation_mish__prompt_kernel_slow0a
  v_mov_b32 v6, v5
  s_nop 1
  v_permlane32_swap_b32 v5, v6
  s_nop 1
  v_max_f32 v5, v5, v6
  v_sub_f32 v152, 0, v5
  v_sub_f32 v153, 0, v5
  v_sub_f32 v154, 0, v5
  v_sub_f32 v155, 0, v5
  v_sub_f32 v156, 0, v5
  v_sub_f32 v157, 0, v5
  v_sub_f32 v158, 0, v5
  v_sub_f32 v159, 0, v5
  v_sub_f32 v160, 0, v5
  v_sub_f32 v161, 0, v5
  v_sub_f32 v162, 0, v5
  v_sub_f32 v163, 0, v5
  v_sub_f32 v164, 0, v5
  v_sub_f32 v165, 0, v5
  v_sub_f32 v166, 0, v5
  v_sub_f32 v167, 0, v5
  v_mov_b32 v120, 0
  v_mov_b32 v121, 0
  v_mov_b32 v122, 0
  v_mov_b32 v123, 0
  v_mov_b32 v124, 0
  v_mov_b32 v125, 0
  v_mov_b32 v126, 0
  v_mov_b32 v127, 0
  v_mov_b32 v128, 0
  v_mov_b32 v129, 0
  v_mov_b32 v130, 0
  v_mov_b32 v131, 0
  v_mov_b32 v132, 0
  v_mov_b32 v133, 0
  v_mov_b32 v134, 0
  v_mov_b32 v135, 0
  v_mov_b32 v2, v1
  s_lshl_b32 s28, s31, 2
  s_add_u32 s28, s28, 4
  v_mul_lo_u32 v6, s28, v4
  v_sub_u32 v6, v3, v6
  v_lshrrev_b32 v7, 3, v4
  s_mov_b32 s20, 0
parallel_sum__softmax_full_mha__dense_activation_mish__prompt_kernel_slow0b:
  ds_read_b128 v[16:19], v2
  ds_read_b128 v[24:27], v6
  ds_read_b128 v[28:31], v6 offset:512
  v_add_u32 v2, 1024, v2
  v_add_u32 v6, v7, v6
  s_waitcnt lgkmcnt(0)
  v_mfma_f32_32x32x16_bf16 v[56:71], v[16:19], v[8:11], v[152:167]
  s_nop 15
  v_exp_f32 v56, v56
  v_exp_f32 v57, v57
  v_exp_f32 v58, v58
  v_exp_f32 v59, v59
  v_exp_f32 v60, v60
  v_exp_f32 v61, v61
  v_exp_f32 v62, v62
  v_exp_f32 v63, v63
  v_exp_f32 v64, v64
  v_exp_f32 v65, v65
  v_exp_f32 v66, v66
  v_exp_f32 v67, v67
  v_exp_f32 v68, v68
  v_exp_f32 v69, v69
  v_exp_f32 v70, v70
  v_exp_f32 v71, v71
  s_nop 0
  v_cvt_pk_bf16_f32 v40, v56, v57
  v_cvt_pk_bf16_f32 v41, v58, v59
  v_cvt_pk_bf16_f32 v42, v60, v61
  v_cvt_pk_bf16_f32 v43, v62, v63
  v_cvt_pk_bf16_f32 v44, v64, v65
  v_cvt_pk_bf16_f32 v45, v66, v67
  v_cvt_pk_bf16_f32 v46, v68, v69
  v_cvt_pk_bf16_f32 v47, v70, v71
  s_nop 1
  v_mfma_f32_32x32x16_bf16 v[120:135], v[24:27], v[40:43], v[120:135]
  v_mfma_f32_32x32x16_bf16 v[120:135], v[28:31], v[44:47], v[120:135]
  s_add_u32 s20, s20, 1
  s_cmp_lt_u32 s20, 64
  s_cbranch_scc1 parallel_sum__softmax_full_mha__dense_activation_mish__prompt_kernel_slow0b
  s_nop 15
  s_branch parallel_sum__softmax_full_mha__dense_activation_mish__prompt_kernel_fin0
parallel_sum__softmax_full_mha__dense_activation_mish__prompt_kernel_slow1:
  v_mov_b32 v2, v1
  v_mov_b32 v5, 0xff800000
  s_mov_b32 s20, 0
parallel_sum__softmax_full_mha__dense_activation_mish__prompt_kernel_slow1a:
  ds_read_b128 v[16:19], v2
  v_add_u32 v2, 1024, v2
  s_waitcnt lgkmcnt(0)
  v_mfma_f32_32x32x16_bf16 v[88:103], v[16:19], v[12:15], 0
  s_nop 15
  v_max3_f32 v5, v5, v88, v89
  v_max3_f32 v5, v5, v90, v91
  v_max3_f32 v5, v5, v92, v93
  v_max3_f32 v5, v5, v94, v95
  v_max3_f32 v5, v5, v96, v97
  v_max3_f32 v5, v5, v98, v99
  v_max3_f32 v5, v5, v100, v101
  v_max3_f32 v5, v5, v102, v103
  s_add_u32 s20, s20, 1
  s_cmp_lt_u32 s20, 64
  s_cbranch_scc1 parallel_sum__softmax_full_mha__dense_activation_mish__prompt_kernel_slow1a
  v_mov_b32 v6, v5
  s_nop 1
  v_permlane32_swap_b32 v5, v6
  s_nop 1
  v_max_f32 v5, v5, v6
  v_sub_f32 v152, 0, v5
  v_sub_f32 v153, 0, v5
  v_sub_f32 v154, 0, v5
  v_sub_f32 v155, 0, v5
  v_sub_f32 v156, 0, v5
  v_sub_f32 v157, 0, v5
  v_sub_f32 v158, 0, v5
  v_sub_f32 v159, 0, v5
  v_sub_f32 v160, 0, v5
  v_sub_f32 v161, 0, v5
  v_sub_f32 v162, 0, v5
  v_sub_f32 v163, 0, v5
  v_sub_f32 v164, 0, v5
  v_sub_f32 v165, 0, v5
  v_sub_f32 v166, 0, v5
  v_sub_f32 v167, 0, v5
  v_mov_b32 v136, 0
  v_mov_b32 v137, 0
  v_mov_b32 v138, 0
  v_mov_b32 v139, 0
  v_mov_b32 v140, 0
  v_mov_b32 v141, 0
  v_mov_b32 v142, 0
  v_mov_b32 v143, 0
  v_mov_b32 v144, 0
  v_mov_b32 v145, 0
  v_mov_b32 v146, 0
  v_mov_b32 v147, 0
  v_mov_b32 v148, 0
  v_mov_b32 v149, 0
  v_mov_b32 v150, 0
  v_mov_b32 v151, 0
  v_mov_b32 v2, v1
  s_lshl_b32 s28, s31, 2
  s_add_u32 s28, s28, 4
  v_mul_lo_u32 v6, s28, v4
  v_sub_u32 v6, v3, v6
  v_lshrrev_b32 v7, 3, v4
  s_mov_b32 s20, 0
parallel_sum__softmax_full_mha__dense_activation_mish__prompt_kernel_slow1b:
  ds_read_b128 v[16:19], v2
  ds_read_b128 v[24:27], v6
  ds_read_b128 v[28:31], v6 offset:512
  v_add_u32 v2, 1024, v2
  v_add_u32 v6, v7, v6
  s_waitcnt lgkmcnt(0)
  v_mfma_f32_32x32x16_bf16 v[88:103], v[16:19], v[12:15], v[152:167]
  s_nop 15
  v_exp_f32 v88, v88
  v_exp_f32 v89, v89
  v_exp_f32 v90, v90
  v_exp_f32 v91, v91
  v_exp_f32 v92, v92
  v_exp_f32 v93, v93
  v_exp_f32 v94, v94
  v_exp_f32 v95, v95
  v_exp_f32 v96, v96
  v_exp_f32 v97, v97
  v_exp_f32 v98, v98
  v_exp_f32 v99, v99
  v_exp_f32 v100, v100
  v_exp_f32 v101, v101
  v_exp_f32 v102, v102
  v_exp_f32 v103, v103
  s_nop 0
  v_cvt_pk_bf16_f32 v48, v88, v89
  v_cvt_pk_bf16_f32 v49, v90, v91
  v_cvt_pk_bf16_f32 v50, v92, v93
  v_cvt_pk_bf16_f32 v51, v94, v95
  v_cvt_pk_bf16_f32 v52, v96, v97
  v_cvt_pk_bf16_f32 v53, v98, v99
  v_cvt_pk_bf16_f32 v54, v100, v101
  v_cvt_pk_bf16_f32 v55, v102, v103
  s_nop 1
  v_mfma_f32_32x32x16_bf16 v[136:151], v[24:27], v[48:51], v[136:151]
  v_mfma_f32_32x32x16_bf16 v[136:151], v[28:31], v[52:55], v[136:151]
  s_add_u32 s20, s20, 1
  s_cmp_lt_u32 s20, 64
  s_cbranch_scc1 parallel_sum__softmax_full_mha__dense_activation_mish__prompt_kernel_slow1b
  s_nop 15
  s_branch parallel_sum__softmax_full_mha__dense_activation_mish__prompt_kernel_fin1
parallel_sum__softmax_full_mha__dense_activation_mish__prompt_kernel_G:
  s_setprio 3
  s_sub_u32 s30, s16, 8
  s_lshl_b32 s22, s30, 11
  s_add_u32 s22, s22, 8192
  s_add_u32 s21, s23, s22
  s_add_u32 s21, s21, 2097152
  s_waitcnt lgkmcnt(0)
  s_mov_b32 s8, s4
  s_and_b32 s9, s5, 0xffff
  s_mov_b32 s10, 0x10000000
  s_mov_b32 s11, 0x00020000
  v_mov_b32 v6, 159744
  v_mov_b32 v10, 0
  v_mov_b32 v11, 0
  v_mov_b32 v12, 0
  v_mov_b32 v13, 0
  v_mov_b32 v14, 4
  ds_write_b128 v6, v[10:13]
  ds_write_b32 v6, v14 offset:16
  ds_write_b32 v6, v10 offset:32
  v_mov_b32 v7, 1
  s_waitcnt lgkmcnt(0)
  s_barrier
  s_mov_b32 m0, s22
  s_mov_b32 s24, s21
  s_add_u32 s25, s24, 2097152
  buffer_load_dwordx4 v1, s[8:11], s24 offen lds
  buffer_load_dwordx4 v1, s[8:11], s24 offen offset:1024 lds
  s_add_u32 m0, s22, 65536
  s_nop 0
  buffer_load_dwordx4 v1, s[8:11], s25 offen lds
  buffer_load_dwordx4 v1, s[8:11], s25 offen offset:1024 lds
  s_add_u32 m0, s22, 32768
  s_add_u32 s24, s21, 32768
  s_add_u32 s25, s24, 2097152
  buffer_load_dwordx4 v1, s[8:11], s24 offen lds
  buffer_load_dwordx4 v1, s[8:11], s24 offen offset:1024 lds
  s_add_u32 m0, s22, 98304
  s_nop 0
  buffer_load_dwordx4 v1, s[8:11], s25 offen lds
  buffer_load_dwordx4 v1, s[8:11], s25 offen offset:1024 lds
  s_add_u32 s22, s22, 8192
  s_add_u32 s21, s21, 8192
  s_mov_b32 m0, s22
  s_mov_b32 s24, s21
  s_add_u32 s25, s24, 2097152
  buffer_load_dwordx4 v1, s[8:11], s24 offen lds
  buffer_load_dwordx4 v1, s[8:11], s24 offen offset:1024 lds
  s_add_u32 m0, s22, 65536
  s_nop 0
  buffer_load_dwordx4 v1, s[8:11], s25 offen lds
  buffer_load_dwordx4 v1, s[8:11], s25 offen offset:1024 lds
  s_add_u32 m0, s22, 32768
  s_add_u32 s24, s21, 32768
  s_add_u32 s25, s24, 2097152
  buffer_load_dwordx4 v1, s[8:11], s24 offen lds
  buffer_load_dwordx4 v1, s[8:11], s24 offen offset:1024 lds
  s_add_u32 m0, s22, 98304
  s_nop 0
  buffer_load_dwordx4 v1, s[8:11], s25 offen lds
  buffer_load_dwordx4 v1, s[8:11], s25 offen offset:1024 lds
  s_add_u32 s22, s22, 8192
  s_add_u32 s21, s21, 8192
  s_waitcnt vmcnt(8)
  s_mov_b64 exec, 1
  ds_add_u32 v6, v7 offset:4
  s_mov_b64 exec, -1
  s_mov_b32 m0, s22
  s_mov_b32 s24, s21
  s_add_u32 s25, s24, 2097152
  buffer_load_dwordx4 v1, s[8:11], s24 offen lds
  buffer_load_dwordx4 v1, s[8:11], s24 offen offset:1024 lds
  s_add_u32 m0, s22, 65536
  s_nop 0
  buffer_load_dwordx4 v1, s[8:11], s25 offen lds
  buffer_load_dwordx4 v1, s[8:11], s25 offen offset:1024 lds
  s_add_u32 m0, s22, 32768
  s_add_u32 s24, s21, 32768
  s_add_u32 s25, s24, 2097152
  buffer_load_dwordx4 v1, s[8:11], s24 offen lds
  buffer_load_dwordx4 v1, s[8:11], s24 offen offset:1024 lds
  s_add_u32 m0, s22, 98304
  s_nop 0
  buffer_load_dwordx4 v1, s[8:11], s25 offen lds
  buffer_load_dwordx4 v1, s[8:11], s25 offen offset:1024 lds
  s_add_u32 s22, s22, 8192
  s_add_u32 s21, s21, 8192
  s_waitcnt vmcnt(8)
  s_mov_b64 exec, 1
  ds_add_u32 v6, v7 offset:8
  s_mov_b64 exec, -1
  s_mul_i32 s22, s17, 294912
  s_add_u32 s22, s22, 8388608
  s_mul_i32 s23, s27, 294912
  s_add_u32 s23, s23, 18874368
  s_mul_i32 s24, s30, 28672
  s_add_u32 s24, s24, 32768
  v_add_u32 v2, s22, v1
  v_add_u32 v4, s23, v1
  v_add_u32 v3, 147456, v2
  v_add_u32 v5, 147456, v4
  s_setprio 0
  buffer_load_dwordx4 v[72:75], v2, s[8:11], s24 offen offset:0
  buffer_load_dwordx4 v[76:79], v3, s[8:11], s24 offen offset:0
  buffer_load_dwordx4 v[80:83], v4, s[8:11], s24 offen offset:0
  buffer_load_dwordx4 v[84:87], v5, s[8:11], s24 offen offset:0
  buffer_load_dwordx4 v[88:91], v2, s[8:11], s24 offen offset:1024
  buffer_load_dwordx4 v[92:95], v3, s[8:11], s24 offen offset:1024
  buffer_load_dwordx4 v[96:99], v4, s[8:11], s24 offen offset:1024
  buffer_load_dwordx4 v[100:103], v5, s[8:11], s24 offen offset:1024
  buffer_load_dwordx4 v[104:107], v2, s[8:11], s24 offen offset:2048
  buffer_load_dwordx4 v[108:111], v3, s[8:11], s24 offen offset:2048
  buffer_load_dwordx4 v[112:115], v4, s[8:11], s24 offen offset:2048
  buffer_load_dwordx4 v[116:119], v5, s[8:11], s24 offen offset:2048
  buffer_load_dwordx4 v[120:123], v2, s[8:11], s24 offen offset:3072
  buffer_load_dwordx4 v[124:127], v3, s[8:11], s24 offen offset:3072
  buffer_load_dwordx4 v[128:131], v4, s[8:11], s24 offen offset:3072
  buffer_load_dwordx4 v[132:135], v5, s[8:11], s24 offen offset:3072
  s_add_u32 s24, s24, 4096
  s_waitcnt vmcnt(16)
  s_mov_b64 exec, 1
  ds_add_u32 v6, v7 offset:12
  s_mov_b64 exec, -1
  s_waitcnt vmcnt(12)
  v_mfma_f32_32x32x16_bf16 v[8:23], v[80:83], v[72:75], 0
  v_mfma_f32_32x32x16_bf16 v[24:39], v[80:83], v[76:79], 0
  v_mfma_f32_32x32x16_bf16 v[40:55], v[84:87], v[72:75], 0
  v_mfma_f32_32x32x16_bf16 v[56:71], v[84:87], v[76:79], 0
  buffer_load_dwordx4 v[72:75], v2, s[8:11], s24 offen offset:0
  buffer_load_dwordx4 v[76:79], v3, s[8:11], s24 offen offset:0
  buffer_load_dwordx4 v[80:83], v4, s[8:11], s24 offen offset:0
  buffer_load_dwordx4 v[84:87], v5, s[8:11], s24 offen offset:0
  s_waitcnt vmcnt(12)
  v_mfma_f32_32x32x16_bf16 v[8:23], v[96:99], v[88:91], v[8:23]
  v_mfma_f32_32x32x16_bf16 v[24:39], v[96:99], v[92:95], v[24:39]
  v_mfma_f32_32x32x16_bf16 v[40:55], v[100:103], v[88:91], v[40:55]
  v_mfma_f32_32x32x16_bf16 v[56:71], v[100:103], v[92:95], v[56:71]
  buffer_load_dwordx4 v[88:91], v2, s[8:11], s24 offen offset:1024
  buffer_load_dwordx4 v[92:95], v3, s[8:11], s24 offen offset:1024
  buffer_load_dwordx4 v[96:99], v4, s[8:11], s24 offen offset:1024
  buffer_load_dwordx4 v[100:103], v5, s[8:11], s24 offen offset:1024
  s_waitcnt vmcnt(12)
  v_mfma_f32_32x32x16_bf16 v[8:23], v[112:115], v[104:107], v[8:23]
  v_mfma_f32_32x32x16_bf16 v[24:39], v[112:115], v[108:111], v[24:39]
  v_mfma_f32_32x32x16_bf16 v[40:55], v[116:119], v[104:107], v[40:55]
  v_mfma_f32_32x32x16_bf16 v[56:71], v[116:119], v[108:111], v[56:71]
  buffer_load_dwordx4 v[104:107], v2, s[8:11], s24 offen offset:2048
  buffer_load_dwordx4 v[108:111], v3, s[8:11], s24 offen offset:2048
  buffer_load_dwordx4 v[112:115], v4, s[8:11], s24 offen offset:2048
  buffer_load_dwordx4 v[116:119], v5, s[8:11], s24 offen offset:2048
  s_waitcnt vmcnt(12)
  v_mfma_f32_32x32x16_bf16 v[8:23], v[128:131], v[120:123], v[8:23]
  v_mfma_f32_32x32x16_bf16 v[24:39], v[128:131], v[124:127], v[24:39]
  v_mfma_f32_32x32x16_bf16 v[40:55], v[132:135], v[120:123], v[40:55]
  v_mfma_f32_32x32x16_bf16 v[56:71], v[132:135], v[124:127], v[56:71]
  buffer_load_dwordx4 v[120:123], v2, s[8:11], s24 offen offset:3072
  buffer_load_dwordx4 v[124:127], v3, s[8:11], s24 offen offset:3072
  buffer_load_dwordx4 v[128:131], v4, s[8:11], s24 offen offset:3072
  buffer_load_dwordx4 v[132:135], v5, s[8:11], s24 offen offset:3072
  s_add_u32 s24, s24, 4096
  s_mov_b32 s28, 5
parallel_sum__softmax_full_mha__dense_activation_mish__prompt_kernel_Gl:
  s_waitcnt vmcnt(12)
  v_mfma_f32_32x32x16_bf16 v[8:23], v[80:83], v[72:75], v[8:23]
  v_mfma_f32_32x32x16_bf16 v[24:39], v[80:83], v[76:79], v[24:39]
  v_mfma_f32_32x32x16_bf16 v[40:55], v[84:87], v[72:75], v[40:55]
  v_mfma_f32_32x32x16_bf16 v[56:71], v[84:87], v[76:79], v[56:71]
  buffer_load_dwordx4 v[72:75], v2, s[8:11], s24 offen offset:0
  buffer_load_dwordx4 v[76:79], v3, s[8:11], s24 offen offset:0
  buffer_load_dwordx4 v[80:83], v4, s[8:11], s24 offen offset:0
  buffer_load_dwordx4 v[84:87], v5, s[8:11], s24 offen offset:0
  s_waitcnt vmcnt(12)
  v_mfma_f32_32x32x16_bf16 v[8:23], v[96:99], v[88:91], v[8:23]
  v_mfma_f32_32x32x16_bf16 v[24:39], v[96:99], v[92:95], v[24:39]
  v_mfma_f32_32x32x16_bf16 v[40:55], v[100:103], v[88:91], v[40:55]
  v_mfma_f32_32x32x16_bf16 v[56:71], v[100:103], v[92:95], v[56:71]
  buffer_load_dwordx4 v[88:91], v2, s[8:11], s24 offen offset:1024
  buffer_load_dwordx4 v[92:95], v3, s[8:11], s24 offen offset:1024
  buffer_load_dwordx4 v[96:99], v4, s[8:11], s24 offen offset:1024
  buffer_load_dwordx4 v[100:103], v5, s[8:11], s24 offen offset:1024
  s_waitcnt vmcnt(12)
  v_mfma_f32_32x32x16_bf16 v[8:23], v[112:115], v[104:107], v[8:23]
  v_mfma_f32_32x32x16_bf16 v[24:39], v[112:115], v[108:111], v[24:39]
  v_mfma_f32_32x32x16_bf16 v[40:55], v[116:119], v[104:107], v[40:55]
  v_mfma_f32_32x32x16_bf16 v[56:71], v[116:119], v[108:111], v[56:71]
  buffer_load_dwordx4 v[104:107], v2, s[8:11], s24 offen offset:2048
  buffer_load_dwordx4 v[108:111], v3, s[8:11], s24 offen offset:2048
  buffer_load_dwordx4 v[112:115], v4, s[8:11], s24 offen offset:2048
  buffer_load_dwordx4 v[116:119], v5, s[8:11], s24 offen offset:2048
  s_waitcnt vmcnt(12)
  v_mfma_f32_32x32x16_bf16 v[8:23], v[128:131], v[120:123], v[8:23]
  v_mfma_f32_32x32x16_bf16 v[24:39], v[128:131], v[124:127], v[24:39]
  v_mfma_f32_32x32x16_bf16 v[40:55], v[132:135], v[120:123], v[40:55]
  v_mfma_f32_32x32x16_bf16 v[56:71], v[132:135], v[124:127], v[56:71]
  buffer_load_dwordx4 v[120:123], v2, s[8:11], s24 offen offset:3072
  buffer_load_dwordx4 v[124:127], v3, s[8:11], s24 offen offset:3072
  buffer_load_dwordx4 v[128:131], v4, s[8:11], s24 offen offset:3072
  buffer_load_dwordx4 v[132:135], v5, s[8:11], s24 offen offset:3072
  s_add_u32 s24, s24, 4096
  s_sub_u32 s28, s28, 1
  s_cmp_lg_u32 s28, 0
  s_cbranch_scc1 parallel_sum__softmax_full_mha__dense_activation_mish__prompt_kernel_Gl
  s_lshl_b32 s35, s30, 13
  s_waitcnt vmcnt(12)
  v_mfma_f32_32x32x16_bf16 v[8:23], v[80:83], v[72:75], v[8:23]
  v_mfma_f32_32x32x16_bf16 v[24:39], v[80:83], v[76:79], v[24:39]
  v_mfma_f32_32x32x16_bf16 v[40:55], v[84:87], v[72:75], v[40:55]
  v_mfma_f32_32x32x16_bf16 v[56:71], v[84:87], v[76:79], v[56:71]
  s_waitcnt vmcnt(8)
  v_mfma_f32_32x32x16_bf16 v[8:23], v[96:99], v[88:91], v[8:23]
  v_mfma_f32_32x32x16_bf16 v[24:39], v[96:99], v[92:95], v[24:39]
  v_mfma_f32_32x32x16_bf16 v[40:55], v[100:103], v[88:91], v[40:55]
  v_mfma_f32_32x32x16_bf16 v[56:71], v[100:103], v[92:95], v[56:71]
  s_waitcnt vmcnt(4)
  v_mfma_f32_32x32x16_bf16 v[8:23], v[112:115], v[104:107], v[8:23]
  v_mfma_f32_32x32x16_bf16 v[24:39], v[112:115], v[108:111], v[24:39]
  v_mfma_f32_32x32x16_bf16 v[40:55], v[116:119], v[104:107], v[40:55]
  v_mfma_f32_32x32x16_bf16 v[56:71], v[116:119], v[108:111], v[56:71]
  s_waitcnt vmcnt(0)
  v_mfma_f32_32x32x16_bf16 v[8:23], v[128:131], v[120:123], v[8:23]
  v_mfma_f32_32x32x16_bf16 v[24:39], v[128:131], v[124:127], v[24:39]
  v_mfma_f32_32x32x16_bf16 v[40:55], v[132:135], v[120:123], v[40:55]
  v_mfma_f32_32x32x16_bf16 v[56:71], v[132:135], v[124:127], v[56:71]
  buffer_load_dwordx4 v[136:139], v4, s[8:11], s35 offen offset:0
  buffer_load_dwordx4 v[140:143], v5, s[8:11], s35 offen offset:0
  buffer_load_dwordx4 v[144:147], v4, s[8:11], s35 offen offset:1024
  buffer_load_dwordx4 v[148:151], v5, s[8:11], s35 offen offset:1024
  buffer_load_dwordx4 v[152:155], v4, s[8:11], s35 offen offset:2048
  buffer_load_dwordx4 v[156:159], v5, s[8:11], s35 offen offset:2048
  buffer_load_dwordx4 v[160:163], v4, s[8:11], s35 offen offset:3072
  buffer_load_dwordx4 v[164:167], v5, s[8:11], s35 offen offset:3072
  s_barrier
  v_add_u32 v2, s35, v2
  v_add_u32 v3, s35, v3
  s_add_u32 s24, s35, 4096
  s_barrier
  s_lshl_b32 s26, s30, 13
  s_add_u32 s26, s26, 73728
  s_add_u32 m0, s26, 0
  s_nop 0
  buffer_load_dwordx4 v4, s[8:11], s24 offen offset:0 lds
  buffer_load_dwordx4 v4, s[8:11], s24 offen offset:1024 lds
  buffer_load_dwordx4 v4, s[8:11], s24 offen offset:2048 lds
  buffer_load_dwordx4 v4, s[8:11], s24 offen offset:3072 lds
  s_add_u32 m0, s26, 4096
  s_nop 0
  buffer_load_dwordx4 v5, s[8:11], s24 offen offset:0 lds
  buffer_load_dwordx4 v5, s[8:11], s24 offen offset:1024 lds
  buffer_load_dwordx4 v5, s[8:11], s24 offen offset:2048 lds
  buffer_load_dwordx4 v5, s[8:11], s24 offen offset:3072 lds
  v_add_u32 v4, s26, v1
  s_lshr_b32 s26, s17, 2
  s_lshl_b32 s26, s26, 2
  s_add_u32 s26, s26, s30
  s_lshl_b32 s26, s26, 7
  s_add_u32 s26, s26, 27262976
  v_mov_b32 v7, s26
  s_mov_b32 s28, 0x10000
parallel_sum__softmax_full_mha__dense_activation_mish__prompt_kernel_Gpoll:
  global_load_dword v6, v7, s[4:5] sc1
  s_waitcnt vmcnt(0)
  v_readfirstlane_b32 s29, v6
  s_nop 1
  s_cmp_ge_u32 s29, 8
  s_cbranch_scc1 parallel_sum__softmax_full_mha__dense_activation_mish__prompt_kernel_Gnp
  s_sub_u32 s28, s28, 1
  s_cmp_lg_u32 s28, 0
  s_cbranch_scc1 parallel_sum__softmax_full_mha__dense_activation_mish__prompt_kernel_Gpoll
parallel_sum__softmax_full_mha__dense_activation_mish__prompt_kernel_Gnp:
  global_load_dwordx4 v[72:75], v2, s[4:5] offset:0 sc1
  global_load_dwordx4 v[76:79], v3, s[4:5] offset:0 sc1
  global_load_dwordx4 v[80:83], v2, s[4:5] offset:1024 sc1
  global_load_dwordx4 v[84:87], v3, s[4:5] offset:1024 sc1
  global_load_dwordx4 v[88:91], v2, s[4:5] offset:2048 sc1
  global_load_dwordx4 v[92:95], v3, s[4:5] offset:2048 sc1
  global_load_dwordx4 v[96:99], v2, s[4:5] offset:3072 sc1
  global_load_dwordx4 v[100:103], v3, s[4:5] offset:3072 sc1
  v_add_u32 v2, 4096, v2
  v_add_u32 v3, 4096, v3
  global_load_dwordx4 v[104:107], v2, s[4:5] offset:0 sc1
  global_load_dwordx4 v[108:111], v3, s[4:5] offset:0 sc1
  global_load_dwordx4 v[112:115], v2, s[4:5] offset:1024 sc1
  global_load_dwordx4 v[116:119], v3, s[4:5] offset:1024 sc1
  global_load_dwordx4 v[120:123], v2, s[4:5] offset:2048 sc1
  global_load_dwordx4 v[124:127], v3, s[4:5] offset:2048 sc1
  global_load_dwordx4 v[128:131], v2, s[4:5] offset:3072 sc1
  global_load_dwordx4 v[132:135], v3, s[4:5] offset:3072 sc1
  v_and_b32 v7, 31, v0
  v_mul_u32_u24 v7, 272, v7
  v_and_b32 v6, 32, v0
  v_lshrrev_b32 v6, 1, v6
  v_add_u32 v7, v7, v6
  s_mul_i32 s26, s30, 17408
  v_add_u32 v6, s26, v7
  s_waitcnt vmcnt(14)
  v_mfma_f32_32x32x16_bf16 v[8:23], v[136:139], v[72:75], v[8:23]
  v_mfma_f32_32x32x16_bf16 v[24:39], v[136:139], v[76:79], v[24:39]
  v_mfma_f32_32x32x16_bf16 v[40:55], v[140:143], v[72:75], v[40:55]
  v_mfma_f32_32x32x16_bf16 v[56:71], v[140:143], v[76:79], v[56:71]
  ds_read_b128 v[136:139], v4 offset:0
  ds_read_b128 v[140:143], v4 offset:4096
  s_waitcnt vmcnt(12)
  v_mfma_f32_32x32x16_bf16 v[8:23], v[144:147], v[80:83], v[8:23]
  v_mfma_f32_32x32x16_bf16 v[24:39], v[144:147], v[84:87], v[24:39]
  v_mfma_f32_32x32x16_bf16 v[40:55], v[148:151], v[80:83], v[40:55]
  v_mfma_f32_32x32x16_bf16 v[56:71], v[148:151], v[84:87], v[56:71]
  ds_read_b128 v[144:147], v4 offset:1024
  ds_read_b128 v[148:151], v4 offset:5120
  s_waitcnt vmcnt(10)
  v_mfma_f32_32x32x16_bf16 v[8:23], v[152:155], v[88:91], v[8:23]
  v_mfma_f32_32x32x16_bf16 v[24:39], v[152:155], v[92:95], v[24:39]
  v_mfma_f32_32x32x16_bf16 v[40:55], v[156:159], v[88:91], v[40:55]
  v_mfma_f32_32x32x16_bf16 v[56:71], v[156:159], v[92:95], v[56:71]
  ds_read_b128 v[152:155], v4 offset:2048
  ds_read_b128 v[156:159], v4 offset:6144
  s_waitcnt vmcnt(8)
  v_mfma_f32_32x32x16_bf16 v[8:23], v[160:163], v[96:99], v[8:23]
  v_mfma_f32_32x32x16_bf16 v[24:39], v[160:163], v[100:103], v[24:39]
  v_mfma_f32_32x32x16_bf16 v[40:55], v[164:167], v[96:99], v[40:55]
  v_mfma_f32_32x32x16_bf16 v[56:71], v[164:167], v[100:103], v[56:71]
  ds_read_b128 v[160:163], v4 offset:3072
  ds_read_b128 v[164:167], v4 offset:7168
  s_waitcnt vmcnt(6) lgkmcnt(6)
  v_mfma_f32_32x32x16_bf16 v[8:23], v[136:139], v[104:107], v[8:23]
  s_waitcnt vmcnt(4) lgkmcnt(4)
  v_mfma_f32_32x32x16_bf16 v[8:23], v[144:147], v[112:115], v[8:23]
  s_waitcnt vmcnt(2) lgkmcnt(2)
  v_mfma_f32_32x32x16_bf16 v[8:23], v[152:155], v[120:123], v[8:23]
  s_waitcnt vmcnt(0) lgkmcnt(0)
  v_mfma_f32_32x32x16_bf16 v[8:23], v[160:163], v[128:131], v[8:23]
  v_mfma_f32_32x32x16_bf16 v[24:39], v[136:139], v[108:111], v[24:39]
  v_mfma_f32_32x32x16_bf16 v[24:39], v[144:147], v[116:119], v[24:39]
  v_mfma_f32_32x32x16_bf16 v[24:39], v[152:155], v[124:127], v[24:39]
  v_mfma_f32_32x32x16_bf16 v[24:39], v[160:163], v[132:135], v[24:39]
  v_mfma_f32_32x32x16_bf16 v[40:55], v[140:143], v[104:107], v[40:55]
  v_mfma_f32_32x32x16_bf16 v[40:55], v[148:151], v[112:115], v[40:55]
  v_mfma_f32_32x32x16_bf16 v[40:55], v[156:159], v[120:123], v[40:55]
  v_mfma_f32_32x32x16_bf16 v[40:55], v[164:167], v[128:131], v[40:55]
  s_nop 3
  ds_write_b128 v6, v[8:11] offset:0
  ds_write_b128 v6, v[12:15] offset:32
  ds_write_b128 v6, v[16:19] offset:64
  ds_write_b128 v6, v[20:23] offset:96
  v_mfma_f32_32x32x16_bf16 v[56:71], v[140:143], v[108:111], v[56:71]
  v_mfma_f32_32x32x16_bf16 v[56:71], v[148:151], v[116:119], v[56:71]
  v_mfma_f32_32x32x16_bf16 v[56:71], v[156:159], v[124:127], v[56:71]
  v_mfma_f32_32x32x16_bf16 v[56:71], v[164:167], v[132:135], v[56:71]
  ds_write_b128 v6, v[24:27] offset:8704
  ds_write_b128 v6, v[28:31] offset:8736
  ds_write_b128 v6, v[32:35] offset:8768
  ds_write_b128 v6, v[36:39] offset:8800
  s_nop 3
  ds_write_b128 v6, v[40:43] offset:128
  ds_write_b128 v6, v[44:47] offset:160
  ds_write_b128 v6, v[48:51] offset:192
  ds_write_b128 v6, v[52:55] offset:224
  s_nop 3
  ds_write_b128 v6, v[56:59] offset:8832
  ds_write_b128 v6, v[60:63] offset:8864
  ds_write_b128 v6, v[64:67] offset:8896
  ds_write_b128 v6, v[68:71] offset:8928
  s_waitcnt lgkmcnt(0)
  s_barrier
  s_branch parallel_sum__softmax_full_mha__dense_activation_mish__prompt_kernel_done
parallel_sum__softmax_full_mha__dense_activation_mish__prompt_kernel_end2:
  s_endpgm
.section .rodata,"a"
.p2align 6
.amdhsa_kernel parallel_sum__softmax_full_mha__dense_activation_mish__prompt_kernel
.amdhsa_next_free_vgpr 168
.amdhsa_next_free_sgpr 96
.amdhsa_accum_offset 168
.amdhsa_group_segment_fixed_size 0
.amdhsa_kernarg_size 80
.amdhsa_user_sgpr_count 2
.amdhsa_user_sgpr_kernarg_segment_ptr 1
.amdhsa_system_sgpr_workgroup_id_x 1
.amdhsa_float_denorm_mode_32 3
.amdhsa_ieee_mode 0
.end_amdhsa_kernel
```
